```python
import torch

def _softmax(x, axis=-1):
    return torch.softmax(x, dim=axis)
def _gelu(x):
    return torch.nn.functional.gelu(x, approximate="tanh")
def _silu(x):
    return torch.nn.functional.silu(x)
def _sigmoid(x):
    return torch.sigmoid(x)
def _layernorm(x, axis=-1, eps=1e-5):
    m = x.mean(dim=axis, keepdim=True)
    v = x.var(dim=axis, keepdim=True, unbiased=False)
    return (x - m) / torch.sqrt(v + eps)
def _scatter_add(tgt, idx, src, axis=0):
    return tgt.clone().index_add_(axis, idx, src)
def _segment_sum(src, seg, n):
    out = torch.zeros((n,) + src.shape[1:], dtype=src.dtype)
    return out.index_add_(0, seg, src)
def _pad(x, pw):
    flat = tuple(v for pair in reversed(pw) for v in pair)
    return torch.nn.functional.pad(x, flat)

kernel_name = 'concat_heads__softmax_full_mha__mha_block__prompt'

def setup_inputs():

    _w = (lambda a: (lambda t: t.to(torch.bfloat16) if t.is_floating_point() else t)(torch.as_tensor(a)))
    def _A_setup():
        B, S, D = 1, 2048, 512
        return {
            "x": _w((lambda *s: torch.randn(*s, dtype=torch.bfloat16) * 0.2)(B, S, D)),
            "wqkv": _w((lambda *s: torch.randn(*s, dtype=torch.bfloat16) * 0.2)(D, 3 * D)),
            "wo": _w((lambda *s: torch.randn(*s, dtype=torch.bfloat16) * 0.05)(D, D)),
        }
    _A_in = _A_setup()

    def _B_setup():
        B, S, D, H = 1, 2048, 512, 32
        return {
            "x": _w((lambda *s: torch.randn(*s, dtype=torch.bfloat16) * 0.2)(B, S, D)),
            "wqkv": _w((lambda *s: torch.randn(*s, dtype=torch.bfloat16) * 0.2)(D, 3 * D)),
            "wo": _w((lambda *s: torch.randn(*s, dtype=torch.bfloat16) * 0.05)(D, D)),
        }
    _B_in = _B_setup()

    return {
        "A_x": _A_in["x"],
        "A_wqkv": _A_in["wqkv"],
        "A_wo": _A_in["wo"],
        "B_x": _B_in["x"],
        "B_wqkv": _B_in["wqkv"],
        "B_wo": _B_in["wo"],
    }

def reference(A_x, A_wqkv, A_wo, B_x, B_wqkv, B_wo):
    def _A_ref(x, wqkv, wo):
        B, S, D = x.shape
        H = 32; Dh = D // H
        qkv = (lambda x, *d: x.permute(*d))((x @ wqkv).reshape(B, S, 3, H, Dh), 2, 0, 3, 1, 4)
        q, k, v = qkv[0], qkv[1], qkv[2]
        scale = Dh ** -0.5
        scores = torch.einsum("bhqd,bhkd->bhqk", q, k) * scale
        p = _softmax(scores, axis=-1)
        o = torch.einsum("bhqk,bhkd->bhqd", p, v)
        return (lambda x, *d: x.permute(*d))(o, 0, 2, 1, 3).reshape(B, S, D) @ wo

    def _B_ref(x, wqkv, wo):
        B, S, D = x.shape
        H = 32
        Dh = D // H
        qkv = (lambda x, *d: x.permute(*d))((x @ wqkv).reshape(B, S, 3, H, Dh), 2, 0, 3, 1, 4)
        q, k, v = qkv[0], qkv[1], qkv[2]
        scores = torch.einsum("bhqd,bhkd->bhqk", q, k) * (Dh ** -0.5)
        p = _softmax(scores, axis=-1)
        o = torch.einsum("bhqk,bhkd->bhqd", p, v)
        return (lambda x, *d: x.permute(*d))(o, 0, 2, 1, 3).reshape(B, S, D) @ wo

    a = _A_ref(A_x, A_wqkv, A_wo)
    b = _B_ref(B_x, B_wqkv, B_wo)
    return torch.concatenate([a, b], axis=-1)
```

```asm
; @launch grid=(256,1,1) block=(512,1,1) lds=163840
.amdgcn_target "amdgcn-amd-amdhsa--gfx950"
.text
.globl concat_heads__softmax_full_mha__mha_block__prompt_kernel
.p2align 8
.type concat_heads__softmax_full_mha__mha_block__prompt_kernel,@function
concat_heads__softmax_full_mha__mha_block__prompt_kernel:
    s_getpc_b64 s[8:9]
    v_lshlrev_b32 v6, 7, v0
    s_lshl_b32 s4, s2, 7
    s_and_b32 s4, s4, 0x7c00
    s_add_u32 s10, s4, 1024
    s_min_u32 s10, s10, L_code_end-concat_heads__softmax_full_mha__mha_block__prompt_kernel-4
    s_mov_b32 s11, 0x20000
    s_cmp_ge_u32 s2, 256
    s_cbranch_scc1 L_end
    buffer_load_dword v246, v6, s[8:11], s4 offen
    s_bfe_u32 s41, s2, 0x10002
    s_mul_i32 s45, s41, 24
    s_load_dwordx4 s[56:59], s[0:1], s45
    s_load_dwordx2 s[60:61], s[0:1], s45 offset:16
    s_load_dwordx4 s[4:7], s[0:1], 48
    s_load_dwordx2 s[62:63], s[0:1], 64
    v_lshrrev_b32 v6, 6, v0
    v_and_b32 v0, 63, v0
    v_readfirstlane_b32 s40, v6
    v_lshlrev_b32 v1, 4, v0
    s_bfe_u32 s42, s2, 0x10001
    s_lshl_b32 s42, s42, 3
    s_bfe_u32 s45, s2, 0x30003
    s_add_u32 s42, s42, s45
    s_and_b32 s43, s2, 1
    s_lshl_b32 s43, s43, 2
    s_lshr_b32 s45, s2, 6
    s_add_u32 s43, s43, s45
    s_lshl_b32 s45, s43, 18
    s_lshl_b32 s46, s41, 4
    s_add_u32 s46, s46, s42
    s_lshl_b32 s47, s46, 18
    s_add_u32 s47, s47, 4194304
    s_lshl_b32 s48, s41, 21
    s_add_u32 s48, s48, 12582912
    s_cmp_lt_u32 s40, 4
    s_cbranch_scc1 L_compute
L_loader:
    s_sub_u32 s49, s40, 4
    s_and_b32 s46, s42, 1
    s_lshl_b32 s46, s46, 2
    s_add_u32 s54, s43, s46
    s_and_b32 s54, s54, 7
    v_lshrrev_b32 v6, 4, v0
    v_and_b32 v7, 7, v0
    v_xor_b32 v6, v6, v7
    v_lshlrev_b32 v6, 4, v6
    v_lshrrev_b32 v7, 3, v0
    v_lshl_add_u32 v100, v7, 10, v6
    v_xor_b32 v101, 64, v100
    v_add_u32 v102, 14336, v100
    v_add_u32 v103, 21504, v101
    v_add_u32 v101, 7168, v101
    s_lshl_b32 s50, s49, 16
    s_lshl_b32 s52, s49, 13
    v_add_u32 v6, 0, v0
    v_mul_u32_u24 v7, 43691, v6
    v_lshrrev_b32 v7, 19, v7
    v_mul_u32_u24 v110, 12, v7
    v_sub_u32 v6, v6, v110
    v_mul_u32_u24 v7, 3072, v7
    v_lshrrev_b32 v110, 2, v6
    v_lshl_add_u32 v7, v110, 10, v7
    v_and_b32 v6, 3, v6
    v_lshl_add_u32 v7, v6, 4, v7
    v_subrev_u32 v104, 0, v7
    v_add_u32 v6, 64, v0
    v_mul_u32_u24 v7, 43691, v6
    v_lshrrev_b32 v7, 19, v7
    v_mul_u32_u24 v110, 12, v7
    v_sub_u32 v6, v6, v110
    v_mul_u32_u24 v7, 3072, v7
    v_lshrrev_b32 v110, 2, v6
    v_lshl_add_u32 v7, v110, 10, v7
    v_and_b32 v6, 3, v6
    v_lshl_add_u32 v7, v6, 4, v7
    v_subrev_u32 v105, 1024, v7
    v_add_u32 v6, 128, v0
    v_mul_u32_u24 v7, 43691, v6
    v_lshrrev_b32 v7, 19, v7
    v_mul_u32_u24 v110, 12, v7
    v_sub_u32 v6, v6, v110
    v_mul_u32_u24 v7, 3072, v7
    v_lshrrev_b32 v110, 2, v6
    v_lshl_add_u32 v7, v110, 10, v7
    v_and_b32 v6, 3, v6
    v_lshl_add_u32 v7, v6, 4, v7
    v_subrev_u32 v106, 2048, v7
    s_mul_i32 s51, s49, 49152
    s_lshl_b32 s46, s42, 6
    s_add_u32 s51, s51, s46
    s_mul_i32 s53, s49, 3072
    s_add_u32 s53, s53, 32768
    s_waitcnt lgkmcnt(0)
    s_add_u32 s8, s56, s45
    s_addc_u32 s9, s57, 0
    s_mov_b32 s10, 262144
    s_mov_b32 s11, 0x20000
    s_mov_b32 s12, s58
    s_mov_b32 s13, s59
    s_mov_b32 s14, 1572864
    s_mov_b32 s15, 0x20000
    s_lshl_b32 s46, s54, 7
    s_add_u32 s46, s46, s50
    s_mov_b32 m0, s52
    s_add_u32 s45, s46, 32768
    buffer_load_dwordx4 v100, s[8:11], s46 offen offset:0 lds
    buffer_load_dwordx4 v101, s[8:11], s46 offen offset:1024 lds
    buffer_load_dwordx4 v102, s[8:11], s46 offen offset:2048 lds
    buffer_load_dwordx4 v103, s[8:11], s46 offen offset:3072 lds
    s_add_u32 m0, s52, 4096
    s_mul_i32 s46, s54, 196608
    buffer_load_dwordx4 v100, s[8:11], s45 offen offset:0 lds
    buffer_load_dwordx4 v101, s[8:11], s45 offen offset:1024 lds
    buffer_load_dwordx4 v102, s[8:11], s45 offen offset:2048 lds
    buffer_load_dwordx4 v103, s[8:11], s45 offen offset:3072 lds
    s_mov_b32 m0, s53
    s_add_u32 s46, s46, s51
    buffer_load_dwordx4 v104, s[12:15], s46 offen offset:0 lds
    buffer_load_dwordx4 v105, s[12:15], s46 offen offset:1024 lds
    buffer_load_dwordx4 v106, s[12:15], s46 offen offset:2048 lds
    s_add_u32 s54, s54, 1
    s_and_b32 s54, s54, 7
    s_add_u32 s52, s52, 45056
    s_add_u32 s53, s53, 45056
    s_cmp_lt_u32 s52, 135168
    s_cselect_b32 s45, 0, 135168
    s_sub_u32 s52, s52, s45
    s_sub_u32 s53, s53, s45
    s_lshl_b32 s46, s54, 7
    s_add_u32 s46, s46, s50
    s_mov_b32 m0, s52
    s_add_u32 s45, s46, 32768
    buffer_load_dwordx4 v100, s[8:11], s46 offen offset:0 lds
    buffer_load_dwordx4 v101, s[8:11], s46 offen offset:1024 lds
    buffer_load_dwordx4 v102, s[8:11], s46 offen offset:2048 lds
    buffer_load_dwordx4 v103, s[8:11], s46 offen offset:3072 lds
    s_add_u32 m0, s52, 4096
    s_mul_i32 s46, s54, 196608
    buffer_load_dwordx4 v100, s[8:11], s45 offen offset:0 lds
    buffer_load_dwordx4 v101, s[8:11], s45 offen offset:1024 lds
    buffer_load_dwordx4 v102, s[8:11], s45 offen offset:2048 lds
    buffer_load_dwordx4 v103, s[8:11], s45 offen offset:3072 lds
    s_mov_b32 m0, s53
    s_add_u32 s46, s46, s51
    buffer_load_dwordx4 v104, s[12:15], s46 offen offset:0 lds
    buffer_load_dwordx4 v105, s[12:15], s46 offen offset:1024 lds
    buffer_load_dwordx4 v106, s[12:15], s46 offen offset:2048 lds
    s_add_u32 s54, s54, 1
    s_and_b32 s54, s54, 7
    s_mov_b32 s16, s60
    s_mov_b32 s17, s61
    s_mov_b32 s18, 524288
    s_mov_b32 s19, 0x20000
    s_add_u32 s20, s62, s47
    s_addc_u32 s21, s63, 0
    s_mov_b32 s22, 262144
    s_mov_b32 s23, 0x20000
    s_add_u32 s24, s62, s48
    s_addc_u32 s25, s63, 0
    s_mov_b32 s26, 2097152
    s_mov_b32 s27, 0x20000
    s_add_u32 s28, s62, 16777216
    s_addc_u32 s29, s63, 0
    s_mov_b32 s30, 4096
    s_mov_b32 s31, 0x20000
    s_mov_b32 s32, s6
    s_mov_b32 s33, s7
    s_mov_b32 s34, 256
    s_mov_b32 s35, 0x20000
    s_mov_b32 s36, s4
    s_mov_b32 s37, s5
    s_mov_b32 s38, 4194304
    s_mov_b32 s39, 0x20000
    s_lshr_b32 s45, s40, 2
    s_lshl_b32 s45, s45, 14
    v_add_u32 v2, s45, v1
    v_and_b32 v6, 15, v0
    v_lshlrev_b32 v6, 4, v6
    v_lshrrev_b32 v7, 5, v0
    v_lshl_add_u32 v6, v7, 8, v6
    s_add_u32 s45, s45, 1024
    v_add_u32 v3, s45, v6
    v_and_b32 v6, 31, v0
    v_subrev_u32 v7, 20, v6
    v_cmp_gt_u32 vcc, 8, v7
    v_mov_b32 v7, 135184
    v_mov_b32 v4, 135248
    v_cndmask_b32 v7, v7, v4, vcc
    v_and_b32 v4, 27, v0
    v_cmp_eq_u32 vcc, 16, v4
    v_subrev_u32 v4, 16, v7
    s_nop 0
    v_cndmask_b32 v7, v7, v4, vcc
    v_cmp_gt_u32 vcc, 16, v6
    v_mov_b32 v6, 32768
    v_mov_b32 v5, 0xdddd
    v_cndmask_b32 v3, v7, v3, vcc
    v_cndmask_b32 v4, 0, v6, vcc
    v_add_u32 v4, v4, v3
    v_lshrrev_b32 v7, 3, v0
    v_lshlrev_b32 v7, 11, v7
    v_and_b32 v251, 7, v0
    v_lshl_add_u32 v251, v251, 4, v7
    v_mov_b64 v[248:249], 0
    v_mov_b32 v244, 0
    v_mov_b32 v247, 0
    v_mov_b64 v[252:253], -1
    v_mov_b64 v[254:255], -1
    v_mov_b64 v[68:69], 0
    v_mov_b64 v[70:71], 0
    v_mov_b64 v[72:73], 0
    v_mov_b64 v[74:75], 0
    v_mov_b64 v[76:77], 0
    v_mov_b64 v[78:79], 0
    v_mov_b64 v[80:81], 0
    v_mov_b64 v[82:83], 0
    v_mov_b64 v[84:85], 0
    v_mov_b64 v[86:87], 0
    v_mov_b64 v[88:89], 0
    v_mov_b64 v[90:91], 0
    v_mov_b64 v[92:93], 0
    v_mov_b64 v[94:95], 0
    v_mov_b64 v[96:97], 0
    v_mov_b64 v[98:99], 0
    s_lshl_b32 s45, s41, 4
    s_add_u32 s45, s45, s42
    s_lshl_b32 s45, s45, 7
    v_and_b32 v6, 31, v0
    v_lshl_add_u32 v242, v6, 2, s45
    v_lshrrev_b32 v6, 2, v0
    v_and_b32 v6, 4, v6
    v_and_b32 v7, 7, v0
    v_xor_b32 v6, v6, v7
    v_lshlrev_b32 v6, 4, v6
    v_lshrrev_b32 v7, 3, v0
    v_lshl_add_u32 v243, v7, 10, v6
    s_cmp_lg_u32 s40, 4
    s_cbranch_scc1 L_ld_noconst
    v_lshrrev_b32 v6, 2, v0
    v_and_b32 v7, 1, v6
    v_lshlrev_b32 v7, 9, v7
    v_lshrrev_b32 v6, 1, v6
    v_lshl_add_u32 v7, v6, 11, v7
    v_and_b32 v6, 1, v0
    v_lshl_add_u32 v7, v6, 4, v7
    v_cmp_eq_u32 vcc, 0, v6
    v_and_b32 v6, 2, v0
    v_lshl_add_u32 v7, v6, 5, v7
    v_mov_b32 v6, 0x3f803f80
    v_add_u32 v7, 135168, v7
    v_cndmask_b32 v108, 0, v6, vcc
    v_cndmask_b32 v109, 0, v6, vcc
    v_cndmask_b32 v110, 0, v6, vcc
    v_cndmask_b32 v111, 0, v6, vcc
    ds_write_b128 v7, v[108:111]
L_ld_noconst:
    s_waitcnt vmcnt(11)
    s_barrier
    s_add_u32 s52, s52, 45056
    s_add_u32 s53, s53, 45056
    s_cmp_lt_u32 s52, 135168
    s_cselect_b32 s45, 0, 135168
    s_sub_u32 s52, s52, s45
    s_sub_u32 s53, s53, s45
    s_lshl_b32 s46, s54, 7
    s_add_u32 s46, s46, s50
    s_mov_b32 m0, s52
    s_add_u32 s45, s46, 32768
    buffer_load_dwordx4 v100, s[8:11], s46 offen offset:0 lds
    buffer_load_dwordx4 v101, s[8:11], s46 offen offset:1024 lds
    buffer_load_dwordx4 v102, s[8:11], s46 offen offset:2048 lds
    buffer_load_dwordx4 v103, s[8:11], s46 offen offset:3072 lds
    s_add_u32 m0, s52, 4096
    s_mul_i32 s46, s54, 196608
    buffer_load_dwordx4 v100, s[8:11], s45 offen offset:0 lds
    buffer_load_dwordx4 v101, s[8:11], s45 offen offset:1024 lds
    buffer_load_dwordx4 v102, s[8:11], s45 offen offset:2048 lds
    buffer_load_dwordx4 v103, s[8:11], s45 offen offset:3072 lds
    s_mov_b32 m0, s53
    s_add_u32 s46, s46, s51
    buffer_load_dwordx4 v104, s[12:15], s46 offen offset:0 lds
    buffer_load_dwordx4 v105, s[12:15], s46 offen offset:1024 lds
    buffer_load_dwordx4 v106, s[12:15], s46 offen offset:2048 lds
    s_add_u32 s54, s54, 1
    s_and_b32 s54, s54, 7
    s_waitcnt vmcnt(11)
    s_barrier
    s_add_u32 s52, s52, 45056
    s_add_u32 s53, s53, 45056
    s_cmp_lt_u32 s52, 135168
    s_cselect_b32 s45, 0, 135168
    s_sub_u32 s52, s52, s45
    s_sub_u32 s53, s53, s45
    s_lshl_b32 s46, s54, 7
    s_add_u32 s46, s46, s50
    s_mov_b32 m0, s52
    s_add_u32 s45, s46, 32768
    buffer_load_dwordx4 v100, s[8:11], s46 offen offset:0 lds
    buffer_load_dwordx4 v101, s[8:11], s46 offen offset:1024 lds
    buffer_load_dwordx4 v102, s[8:11], s46 offen offset:2048 lds
    buffer_load_dwordx4 v103, s[8:11], s46 offen offset:3072 lds
    s_add_u32 m0, s52, 4096
    s_mul_i32 s46, s54, 196608
    buffer_load_dwordx4 v100, s[8:11], s45 offen offset:0 lds
    buffer_load_dwordx4 v101, s[8:11], s45 offen offset:1024 lds
    buffer_load_dwordx4 v102, s[8:11], s45 offen offset:2048 lds
    buffer_load_dwordx4 v103, s[8:11], s45 offen offset:3072 lds
    s_mov_b32 m0, s53
    s_add_u32 s46, s46, s51
    buffer_load_dwordx4 v104, s[12:15], s46 offen offset:0 lds
    buffer_load_dwordx4 v105, s[12:15], s46 offen offset:1024 lds
    buffer_load_dwordx4 v106, s[12:15], s46 offen offset:2048 lds
    s_add_u32 s54, s54, 1
    s_and_b32 s54, s54, 7
    s_mov_b32 s44, 2
L_ld_loop:
    s_waitcnt vmcnt(11)
L_ld_loop2:
    s_barrier
    s_add_u32 s52, s52, 45056
    s_add_u32 s53, s53, 45056
    s_cmp_lt_u32 s52, 135168
    s_cselect_b32 s45, 0, 135168
    s_sub_u32 s52, s52, s45
    s_sub_u32 s53, s53, s45
    s_lshl_b32 s46, s54, 7
    s_add_u32 s46, s46, s50
    s_mov_b32 m0, s52
    s_add_u32 s45, s46, 32768
    buffer_load_dwordx4 v100, s[8:11], s46 offen offset:0 lds
    buffer_load_dwordx4 v101, s[8:11], s46 offen offset:1024 lds
    buffer_load_dwordx4 v102, s[8:11], s46 offen offset:2048 lds
    buffer_load_dwordx4 v103, s[8:11], s46 offen offset:3072 lds
    s_add_u32 m0, s52, 4096
    s_mul_i32 s46, s54, 196608
    buffer_load_dwordx4 v100, s[8:11], s45 offen offset:0 lds
    buffer_load_dwordx4 v101, s[8:11], s45 offen offset:1024 lds
    buffer_load_dwordx4 v102, s[8:11], s45 offen offset:2048 lds
    buffer_load_dwordx4 v103, s[8:11], s45 offen offset:3072 lds
    s_mov_b32 m0, s53
    s_add_u32 s46, s46, s51
    buffer_load_dwordx4 v104, s[12:15], s46 offen offset:0 lds
    buffer_load_dwordx4 v105, s[12:15], s46 offen offset:1024 lds
    buffer_load_dwordx4 v106, s[12:15], s46 offen offset:2048 lds
    s_add_u32 s54, s54, 1
    s_and_b32 s54, s54, 7
    s_add_u32 s44, s44, 1
    s_cmp_lt_u32 s44, 6
    s_cbranch_scc1 L_ld_loop
    s_waitcnt vmcnt(11)
    s_barrier
    s_waitcnt vmcnt(0)
    s_barrier
    s_cmp_lg_u32 s40, 4
    s_cbranch_scc1 L_ld_nocert
    s_lshl_b32 s45, s41, 4
    s_add_u32 s45, s45, s42
    s_lshl_b32 s45, s45, 3
    v_mov_b32 v7, s45
    s_mov_b32 s48, 0
L_spin_cert1:
    buffer_load_dword v241, v7, s[32:35], 0 offen sc1
    s_add_u32 s48, s48, 1
    s_waitcnt vmcnt(0)
    v_cmp_gt_u32 vcc, 8, v241
    s_cmp_ge_u32 s48, 1048576
    s_cbranch_scc1 L_spun_cert1
    s_cbranch_vccnz L_spin_cert1
L_spun_cert1:
L_ld_nocert:
    s_lshl_b32 s45, s49, 11
    s_add_u32 s45, s45, 155648
    v_add_u32 v6, s45, v1
    s_add_u32 s8, s20, 131072
    s_addc_u32 s9, s21, 0
    s_mov_b32 s10, 131072
    s_mov_b32 s11, 0x20000
    s_lshl_b32 s49, s40, 11
    s_add_u32 s50, s49, 16384
    s_add_u32 s51, s49, 32768
    s_add_u32 s52, s49, 49152
    s_cmp_gt_u32 s43, 0
    s_cselect_b32 s45, 0, 1
    s_lshl_b32 s48, s45, 2
    s_lshl_b32 s61, 15, s48
    s_lshl_b32 s45, s45, 14
    s_add_u32 s4, s45, s49
    s_cmp_gt_u32 s43, 1
    s_cselect_b32 s45, 1, 2
    s_lshl_b32 s45, s45, 14
    s_add_u32 s5, s45, s49
    s_cmp_gt_u32 s43, 2
    s_cselect_b32 s45, 2, 3
    s_lshl_b32 s45, s45, 14
    s_add_u32 s6, s45, s49
    s_cmp_gt_u32 s43, 3
    s_cselect_b32 s45, 3, 4
    s_lshl_b32 s45, s45, 14
    s_add_u32 s7, s45, s49
    s_cmp_gt_u32 s43, 4
    s_cselect_b32 s45, 4, 5
    s_lshl_b32 s45, s45, 14
    s_add_u32 s12, s45, s49
    s_cmp_gt_u32 s43, 5
    s_cselect_b32 s45, 5, 6
    s_lshl_b32 s45, s45, 14
    s_add_u32 s13, s45, s49
    s_cmp_gt_u32 s43, 6
    s_cselect_b32 s45, 6, 7
    s_lshl_b32 s45, s45, 14
    s_add_u32 s14, s45, s49
    s_lshr_b32 s60, s43, 1
    s_min_u32 s60, s60, 2
    s_cmp_ge_u32 s40, 4
    s_cselect_b32 s60, 3, s60
    s_and_b32 s54, s42, 7
    s_lshl_b32 s45, s54, 7
    s_lshl_b32 s55, s40, 16
    s_add_u32 s55, s55, s45
    s_lshl_b32 s53, s40, 13
    s_add_u32 s53, s53, 65536
    s_and_b32 s45, s40, 3
    s_lshl_b32 s45, s45, 1
    s_lshl_b32 s46, s43, 3
    s_add_u32 s45, s45, s46
    s_lshl_b32 s62, s45, 15
    s_lshr_b32 s46, s40, 2
    s_lshl_b32 s47, s42, 1
    s_add_u32 s46, s46, s47
    s_lshl_b32 s47, s46, 10
    s_add_u32 s62, s62, s47
    s_add_u32 s63, s62, 32768
    s_lshr_b32 s45, s42, 3
    s_lshl_b32 s45, s45, 2
    s_and_b32 s46, s40, 3
    s_add_u32 s45, s45, s46
    s_lshl_b32 s46, s43, 3
    s_add_u32 s45, s45, s46
    s_lshl_b32 s45, s45, 1
    s_lshr_b32 s46, s40, 2
    s_add_u32 s45, s45, s46
    s_lshl_b32 s1, s45, 15
    s_lshl_b32 s45, s41, 10
    s_add_u32 s1, s1, s45
    s_lshl_b32 s45, s54, 7
    s_add_u32 s1, s1, s45
    s_waitcnt lgkmcnt(0)
    s_barrier
    ds_read_b128 v[8:11], v6
    ds_read_b128 v[12:15], v6 offset:1024
    s_branch L_attn
L_compute:
    s_waitcnt lgkmcnt(0)
    s_mov_b32 s16, s60
    s_mov_b32 s17, s61
    s_mov_b32 s18, 524288
    s_mov_b32 s19, 0x20000
    s_add_u32 s20, s62, s47
    s_addc_u32 s21, s63, 0
    s_mov_b32 s22, 262144
    s_mov_b32 s23, 0x20000
    s_add_u32 s24, s62, s48
    s_addc_u32 s25, s63, 0
    s_mov_b32 s26, 2097152
    s_mov_b32 s27, 0x20000
    s_add_u32 s28, s62, 16777216
    s_addc_u32 s29, s63, 0
    s_mov_b32 s30, 4096
    s_mov_b32 s31, 0x20000
    s_mov_b32 s32, s6
    s_mov_b32 s33, s7
    s_mov_b32 s34, 256
    s_mov_b32 s35, 0x20000
    s_mov_b32 s36, s4
    s_mov_b32 s37, s5
    s_mov_b32 s38, 4194304
    s_mov_b32 s39, 0x20000
    s_cmp_lg_u32 s40, 0
    s_cbranch_scc1 L_cp_noclear
    s_lshl_b32 s45, s41, 4
    s_add_u32 s45, s45, s42
    s_lshl_b32 s46, s45, 7
    s_lshl_b32 s47, s43, 4
    s_add_u32 s46, s46, s47
    v_lshl_add_u32 v6, v0, 2, s46
    v_mov_b32 v7, 0
    s_mov_b64 exec, 0xf
    buffer_store_dword v7, v6, s[28:31], 0 offen sc1
    s_mov_b64 exec, -1
L_cp_noclear:
    s_lshr_b32 s45, s40, 2
    s_lshl_b32 s45, s45, 14
    v_add_u32 v2, s45, v1
    v_and_b32 v6, 15, v0
    v_lshlrev_b32 v6, 4, v6
    v_lshrrev_b32 v7, 5, v0
    v_lshl_add_u32 v6, v7, 8, v6
    s_add_u32 s45, s45, 1024
    v_add_u32 v3, s45, v6
    v_and_b32 v6, 31, v0
    v_subrev_u32 v7, 20, v6
    v_cmp_gt_u32 vcc, 8, v7
    v_mov_b32 v7, 135184
    v_mov_b32 v4, 135248
    v_cndmask_b32 v7, v7, v4, vcc
    v_and_b32 v4, 27, v0
    v_cmp_eq_u32 vcc, 16, v4
    v_subrev_u32 v4, 16, v7
    s_nop 0
    v_cndmask_b32 v7, v7, v4, vcc
    v_cmp_gt_u32 vcc, 16, v6
    v_mov_b32 v6, 32768
    v_mov_b32 v5, 0xdddd
    v_cndmask_b32 v3, v7, v3, vcc
    v_cndmask_b32 v4, 0, v6, vcc
    v_add_u32 v4, v4, v3
    v_lshrrev_b32 v7, 3, v0
    v_lshlrev_b32 v7, 11, v7
    v_and_b32 v251, 7, v0
    v_lshl_add_u32 v251, v251, 4, v7
    v_mov_b64 v[248:249], 0
    v_mov_b32 v244, 0
    v_mov_b32 v247, 0
    v_mov_b64 v[252:253], -1
    v_mov_b64 v[254:255], -1
    v_mov_b64 v[68:69], 0
    v_mov_b64 v[70:71], 0
    v_mov_b64 v[72:73], 0
    v_mov_b64 v[74:75], 0
    v_mov_b64 v[76:77], 0
    v_mov_b64 v[78:79], 0
    v_mov_b64 v[80:81], 0
    v_mov_b64 v[82:83], 0
    v_mov_b64 v[84:85], 0
    v_mov_b64 v[86:87], 0
    v_mov_b64 v[88:89], 0
    v_mov_b64 v[90:91], 0
    v_mov_b64 v[92:93], 0
    v_mov_b64 v[94:95], 0
    v_mov_b64 v[96:97], 0
    v_mov_b64 v[98:99], 0
    s_lshl_b32 s45, s41, 4
    s_add_u32 s45, s45, s42
    s_lshl_b32 s45, s45, 7
    v_and_b32 v6, 31, v0
    v_lshl_add_u32 v242, v6, 2, s45
    v_lshrrev_b32 v6, 2, v0
    v_and_b32 v6, 4, v6
    v_and_b32 v7, 7, v0
    v_xor_b32 v6, v6, v7
    v_lshlrev_b32 v6, 4, v6
    v_lshrrev_b32 v7, 3, v0
    v_lshl_add_u32 v243, v7, 10, v6
    v_and_b32 v6, 31, v0
    s_lshl_b32 s45, s40, 13
    v_lshl_add_u32 v100, v6, 7, s45
    v_bfe_u32 v6, v0, 1, 3
    v_lshrrev_b32 v7, 5, v0
    v_xor_b32 v6, v6, v7
    v_xor_b32 v7, 0, v6
    v_lshl_add_u32 v236, v7, 4, v100
    v_xor_b32 v7, 2, v6
    v_lshl_add_u32 v237, v7, 4, v100
    v_xor_b32 v7, 4, v6
    v_lshl_add_u32 v238, v7, 4, v100
    v_xor_b32 v7, 6, v6
    v_lshl_add_u32 v239, v7, 4, v100
    v_lshrrev_b32 v6, 5, v0
    v_bfe_u32 v7, v0, 2, 2
    v_lshl_add_u32 v6, v6, 3, v7
    v_mul_u32_u24 v6, 192, v6
    v_bfe_u32 v7, v0, 4, 1
    v_lshl_add_u32 v6, v7, 5, v6
    v_and_b32 v7, 3, v0
    v_lshl_add_u32 v6, v7, 3, v6
    v_add_u32 v240, 32768, v6
    v_mov_b64 v[100:101], 0
    v_mov_b64 v[102:103], 0
    v_mov_b64 v[104:105], 0
    v_mov_b64 v[106:107], 0
    v_mov_b64 v[108:109], 0
    v_mov_b64 v[110:111], 0
    v_mov_b64 v[112:113], 0
    v_mov_b64 v[114:115], 0
    v_mov_b64 v[116:117], 0
    v_mov_b64 v[118:119], 0
    v_mov_b64 v[120:121], 0
    v_mov_b64 v[122:123], 0
    v_mov_b64 v[124:125], 0
    v_mov_b64 v[126:127], 0
    v_mov_b64 v[128:129], 0
    v_mov_b64 v[130:131], 0
    v_mov_b64 v[132:133], 0
    v_mov_b64 v[134:135], 0
    v_mov_b64 v[136:137], 0
    v_mov_b64 v[138:139], 0
    v_mov_b64 v[140:141], 0
    v_mov_b64 v[142:143], 0
    v_mov_b64 v[144:145], 0
    v_mov_b64 v[146:147], 0
    v_mov_b64 v[148:149], 0
    v_mov_b64 v[150:151], 0
    v_mov_b64 v[152:153], 0
    v_mov_b64 v[154:155], 0
    v_mov_b64 v[156:157], 0
    v_mov_b64 v[158:159], 0
    v_mov_b64 v[160:161], 0
    v_mov_b64 v[162:163], 0
    v_mov_b64 v[164:165], 0
    v_mov_b64 v[166:167], 0
    v_mov_b64 v[168:169], 0
    v_mov_b64 v[170:171], 0
    v_mov_b64 v[172:173], 0
    v_mov_b64 v[174:175], 0
    v_mov_b64 v[176:177], 0
    v_mov_b64 v[178:179], 0
    v_mov_b64 v[180:181], 0
    v_mov_b64 v[182:183], 0
    v_mov_b64 v[184:185], 0
    v_mov_b64 v[186:187], 0
    v_mov_b64 v[188:189], 0
    v_mov_b64 v[190:191], 0
    v_mov_b64 v[192:193], 0
    v_mov_b64 v[194:195], 0
    v_and_b32 v6, 0x33, v0
    v_bfe_u32 v7, v0, 2, 1
    v_lshl_or_b32 v6, v7, 3, v6
    v_bfe_u32 v7, v0, 3, 1
    v_lshl_or_b32 v6, v7, 2, v6
    v_lshlrev_b32 v244, 4, v6
    s_lshl_b32 s45, s40, 12
    v_add_u32 v245, s45, v244
    v_and_b32 v6, 15, v0
    v_lshlrev_b32 v6, 4, v6
    v_lshrrev_b32 v7, 5, v0
    v_lshl_add_u32 v6, v7, 8, v6
    v_add_u32 v6, 1024, v6
    v_bfe_u32 v7, v0, 4, 1
    v_lshl_add_u32 v247, v7, 17, v6
    v_lshl_add_u32 v6, v7, 14, v6
    v_add_u32 v248, s45, v6
    s_lshr_b32 s45, s45, 1
    s_add_u32 s45, s45, 155648
    v_add_u32 v249, s45, v1
    s_add_u32 s8, s20, 131072
    s_addc_u32 s9, s21, 0
    s_mov_b32 s10, 131072
    s_mov_b32 s11, 0x20000
    s_lshl_b32 s49, s40, 11
    s_add_u32 s50, s49, 16384
    s_add_u32 s51, s49, 32768
    s_add_u32 s52, s49, 49152
    s_cmp_gt_u32 s43, 0
    s_cselect_b32 s45, 0, 1
    s_lshl_b32 s48, s45, 2
    s_lshl_b32 s61, 15, s48
    s_lshl_b32 s45, s45, 14
    s_add_u32 s4, s45, s49
    s_cmp_gt_u32 s43, 1
    s_cselect_b32 s45, 1, 2
    s_lshl_b32 s45, s45, 14
    s_add_u32 s5, s45, s49
    s_cmp_gt_u32 s43, 2
    s_cselect_b32 s45, 2, 3
    s_lshl_b32 s45, s45, 14
    s_add_u32 s6, s45, s49
    s_cmp_gt_u32 s43, 3
    s_cselect_b32 s45, 3, 4
    s_lshl_b32 s45, s45, 14
    s_add_u32 s7, s45, s49
    s_cmp_gt_u32 s43, 4
    s_cselect_b32 s45, 4, 5
    s_lshl_b32 s45, s45, 14
    s_add_u32 s12, s45, s49
    s_cmp_gt_u32 s43, 5
    s_cselect_b32 s45, 5, 6
    s_lshl_b32 s45, s45, 14
    s_add_u32 s13, s45, s49
    s_cmp_gt_u32 s43, 6
    s_cselect_b32 s45, 6, 7
    s_lshl_b32 s45, s45, 14
    s_add_u32 s14, s45, s49
    s_lshr_b32 s60, s43, 1
    s_min_u32 s60, s60, 2
    s_cmp_ge_u32 s40, 4
    s_cselect_b32 s60, 3, s60
    s_and_b32 s54, s42, 7
    s_lshl_b32 s45, s54, 7
    s_lshl_b32 s55, s40, 16
    s_add_u32 s55, s55, s45
    s_lshl_b32 s53, s40, 13
    s_add_u32 s53, s53, 65536
    s_and_b32 s45, s40, 3
    s_lshl_b32 s45, s45, 1
    s_lshl_b32 s46, s43, 3
    s_add_u32 s45, s45, s46
    s_lshl_b32 s62, s45, 15
    s_lshr_b32 s46, s40, 2
    s_lshl_b32 s47, s42, 1
    s_add_u32 s46, s46, s47
    s_lshl_b32 s47, s46, 10
    s_add_u32 s62, s62, s47
    s_add_u32 s63, s62, 32768
    s_lshr_b32 s45, s42, 3
    s_lshl_b32 s45, s45, 2
    s_and_b32 s46, s40, 3
    s_add_u32 s45, s45, s46
    s_lshl_b32 s46, s43, 3
    s_add_u32 s45, s45, s46
    s_lshl_b32 s45, s45, 1
    s_lshr_b32 s46, s40, 2
    s_add_u32 s45, s45, s46
    s_lshl_b32 s1, s45, 15
    s_lshl_b32 s45, s41, 10
    s_add_u32 s1, s1, s45
    s_lshl_b32 s45, s54, 7
    s_add_u32 s1, s1, s45
    s_lshl_b32 s45, s40, 12
    s_lshl_b32 s58, s43, 14
    s_add_u32 s58, s58, s45
    s_add_u32 s59, s58, 131072
    s_mov_b32 s44, 0
    s_mov_b32 s56, 0
    s_mov_b32 s57, 45056
    s_cmp_lg_u32 s40, 0
    s_cbranch_scc1 L_cp_nocount
    s_lshl_b32 s45, s41, 4
    s_add_u32 s45, s45, s42
    s_lshl_b32 s45, s45, 3
    s_mov_b64 exec, 1
    v_mov_b32 v6, s45
    v_mov_b32 v7, 1
    s_waitcnt vmcnt(0)
    buffer_atomic_add v7, v6, s[32:35], 0 offen sc1
    s_mov_b64 exec, -1
L_cp_nocount:
    s_barrier
    ds_read_b128 v[196:199], v236 offset:0
    ds_read_b64_tr_b16 v[204:205], v240 offset:0
    ds_read_b64_tr_b16 v[206:207], v240 offset:768
    ds_read_b128 v[200:203], v236 offset:4096
    ds_read_b64_tr_b16 v[208:209], v240 offset:64
    ds_read_b64_tr_b16 v[210:211], v240 offset:832
    ds_read_b64_tr_b16 v[212:213], v240 offset:128
    ds_read_b64_tr_b16 v[214:215], v240 offset:896
L_cp_loop:
    s_waitcnt lgkmcnt(5)
    v_mfma_f32_32x32x16_bf16 v[100:115], v[204:207], v[196:199], v[100:115]
    ds_read_b128 v[216:219], v237 offset:0
    ds_read_b64_tr_b16 v[224:225], v240 offset:3072
    s_waitcnt lgkmcnt(6)
    v_mfma_f32_32x32x16_bf16 v[116:131], v[204:207], v[200:203], v[116:131]
    ds_read_b64_tr_b16 v[226:227], v240 offset:3840
    ds_read_b128 v[220:223], v237 offset:4096
    s_waitcnt lgkmcnt(6)
    v_mfma_f32_32x32x16_bf16 v[132:147], v[208:211], v[196:199], v[132:147]
    ds_read_b64_tr_b16 v[228:229], v240 offset:3136
    ds_read_b64_tr_b16 v[230:231], v240 offset:3904
    v_mfma_f32_32x32x16_bf16 v[148:163], v[208:211], v[200:203], v[148:163]
    ds_read_b64_tr_b16 v[232:233], v240 offset:3200
    ds_read_b64_tr_b16 v[234:235], v240 offset:3968
    s_waitcnt lgkmcnt(8)
    v_mfma_f32_32x32x16_bf16 v[164:179], v[196:199], v[212:215], v[164:179]
    v_mfma_f32_32x32x16_bf16 v[180:195], v[200:203], v[212:215], v[180:195]
    s_waitcnt lgkmcnt(5)
    v_mfma_f32_32x32x16_bf16 v[100:115], v[224:227], v[216:219], v[100:115]
    ds_read_b128 v[196:199], v238 offset:0
    ds_read_b64_tr_b16 v[204:205], v240 offset:6144
    s_waitcnt lgkmcnt(6)
    v_mfma_f32_32x32x16_bf16 v[116:131], v[224:227], v[220:223], v[116:131]
    ds_read_b64_tr_b16 v[206:207], v240 offset:6912
    ds_read_b128 v[200:203], v238 offset:4096
    s_waitcnt lgkmcnt(6)
    v_mfma_f32_32x32x16_bf16 v[132:147], v[228:231], v[216:219], v[132:147]
    ds_read_b64_tr_b16 v[208:209], v240 offset:6208
    ds_read_b64_tr_b16 v[210:211], v240 offset:6976
    v_mfma_f32_32x32x16_bf16 v[148:163], v[228:231], v[220:223], v[148:163]
    ds_read_b64_tr_b16 v[212:213], v240 offset:6272
    ds_read_b64_tr_b16 v[214:215], v240 offset:7040
    s_waitcnt lgkmcnt(8)
    v_mfma_f32_32x32x16_bf16 v[164:179], v[216:219], v[232:235], v[164:179]
    v_mfma_f32_32x32x16_bf16 v[180:195], v[220:223], v[232:235], v[180:195]
    s_waitcnt lgkmcnt(5)
    v_mfma_f32_32x32x16_bf16 v[100:115], v[204:207], v[196:199], v[100:115]
    ds_read_b128 v[216:219], v239 offset:0
    ds_read_b64_tr_b16 v[224:225], v240 offset:9216
    s_waitcnt lgkmcnt(6)
    v_mfma_f32_32x32x16_bf16 v[116:131], v[204:207], v[200:203], v[116:131]
    ds_read_b64_tr_b16 v[226:227], v240 offset:9984
    ds_read_b128 v[220:223], v239 offset:4096
    s_waitcnt lgkmcnt(6)
    v_mfma_f32_32x32x16_bf16 v[132:147], v[208:211], v[196:199], v[132:147]
    ds_read_b64_tr_b16 v[228:229], v240 offset:9280
    ds_read_b64_tr_b16 v[230:231], v240 offset:10048
    v_mfma_f32_32x32x16_bf16 v[148:163], v[208:211], v[200:203], v[148:163]
    ds_read_b64_tr_b16 v[232:233], v240 offset:9344
    ds_read_b64_tr_b16 v[234:235], v240 offset:10112
    s_waitcnt lgkmcnt(8)
    v_mfma_f32_32x32x16_bf16 v[164:179], v[196:199], v[212:215], v[164:179]
    v_mfma_f32_32x32x16_bf16 v[180:195], v[200:203], v[212:215], v[180:195]
    s_add_u32 s56, s56, 1
    s_cmp_eq_u32 s56, 3
    s_cselect_b32 s45, 4294877184, s57
    s_cselect_b32 s56, 0, s56
    s_add_u32 s44, s44, 1
    s_waitcnt lgkmcnt(0)
    s_barrier
    v_add_u32 v236, s45, v236
    v_add_u32 v237, s45, v237
    v_add_u32 v238, s45, v238
    v_add_u32 v239, s45, v239
    v_add_u32 v240, s45, v240
    s_cmp_eq_u32 s44, 7
    s_cbranch_scc1 L_cp_last
    v_mfma_f32_32x32x16_bf16 v[100:115], v[224:227], v[216:219], v[100:115]
    ds_read_b128 v[196:199], v236 offset:0
    ds_read_b64_tr_b16 v[204:205], v240 offset:0
    v_mfma_f32_32x32x16_bf16 v[116:131], v[224:227], v[220:223], v[116:131]
    ds_read_b64_tr_b16 v[206:207], v240 offset:768
    ds_read_b128 v[200:203], v236 offset:4096
    v_mfma_f32_32x32x16_bf16 v[132:147], v[228:231], v[216:219], v[132:147]
    ds_read_b64_tr_b16 v[208:209], v240 offset:64
    ds_read_b64_tr_b16 v[210:211], v240 offset:832
    v_mfma_f32_32x32x16_bf16 v[148:163], v[228:231], v[220:223], v[148:163]
    ds_read_b64_tr_b16 v[212:213], v240 offset:128
    ds_read_b64_tr_b16 v[214:215], v240 offset:896
    v_mfma_f32_32x32x16_bf16 v[164:179], v[216:219], v[232:235], v[164:179]
    v_mfma_f32_32x32x16_bf16 v[180:195], v[220:223], v[232:235], v[180:195]
    s_branch L_cp_loop
L_cp_last:
    v_mfma_f32_32x32x16_bf16 v[100:115], v[224:227], v[216:219], v[100:115]
    ds_read_b128 v[16:19], v236 offset:0
    ds_read_b64_tr_b16 v[48:49], v240 offset:64
    v_mfma_f32_32x32x16_bf16 v[116:131], v[224:227], v[220:223], v[116:131]
    ds_read_b64_tr_b16 v[50:51], v240 offset:832
    ds_read_b128 v[20:23], v236 offset:4096
    v_mfma_f32_32x32x16_bf16 v[132:147], v[228:231], v[216:219], v[132:147]
    ds_read_b128 v[24:27], v237 offset:0
    ds_read_b64_tr_b16 v[52:53], v240 offset:3136
    v_mfma_f32_32x32x16_bf16 v[148:163], v[228:231], v[220:223], v[148:163]
    ds_read_b64_tr_b16 v[54:55], v240 offset:3904
    ds_read_b128 v[28:31], v237 offset:4096
    v_mfma_f32_32x32x16_bf16 v[164:179], v[216:219], v[232:235], v[164:179]
    ds_read_b128 v[32:35], v238 offset:0
    ds_read_b64_tr_b16 v[56:57], v240 offset:6208
    v_mfma_f32_32x32x16_bf16 v[180:195], v[220:223], v[232:235], v[180:195]
    ds_read_b64_tr_b16 v[58:59], v240 offset:6976
    ds_read_b128 v[36:39], v238 offset:4096
    s_waitcnt lgkmcnt(9)
    v_mfma_f32_32x32x16_bf16 v[132:147], v[48:51], v[16:19], v[132:147]
    ds_read_b128 v[40:43], v239 offset:0
    ds_read_b64_tr_b16 v[60:61], v240 offset:9280
    s_waitcnt lgkmcnt(10)
    v_mfma_f32_32x32x16_bf16 v[148:163], v[48:51], v[20:23], v[148:163]
    ds_read_b64_tr_b16 v[62:63], v240 offset:10048
    ds_read_b128 v[44:47], v239 offset:4096
    s_waitcnt lgkmcnt(9)
    v_mfma_f32_32x32x16_bf16 v[132:147], v[52:55], v[24:27], v[132:147]
    ds_read_b64_tr_b16 v[196:197], v240 offset:128
    ds_read_b64_tr_b16 v[198:199], v240 offset:896
    s_waitcnt lgkmcnt(10)
    v_mfma_f32_32x32x16_bf16 v[148:163], v[52:55], v[28:31], v[148:163]
    ds_read_b64_tr_b16 v[200:201], v240 offset:3200
    ds_read_b64_tr_b16 v[202:203], v240 offset:3968
    s_waitcnt lgkmcnt(9)
    v_mfma_f32_32x32x16_bf16 v[132:147], v[56:59], v[32:35], v[132:147]
    ds_read_b64_tr_b16 v[204:205], v240 offset:6272
    ds_read_b64_tr_b16 v[206:207], v240 offset:7040
    s_waitcnt lgkmcnt(10)
    v_mfma_f32_32x32x16_bf16 v[148:163], v[56:59], v[36:39], v[148:163]
    ds_read_b64_tr_b16 v[208:209], v240 offset:9344
    ds_read_b64_tr_b16 v[210:211], v240 offset:10112
    s_waitcnt lgkmcnt(9)
    v_mfma_f32_32x32x16_bf16 v[132:147], v[60:63], v[40:43], v[132:147]
    s_waitcnt lgkmcnt(8)
    v_mfma_f32_32x32x16_bf16 v[148:163], v[60:63], v[44:47], v[148:163]
    s_mov_b32 s46, 0x3eb8aa3b
    s_mov_b32 s47, s46
    s_waitcnt lgkmcnt(6)
    v_mfma_f32_32x32x16_bf16 v[164:179], v[16:19], v[196:199], v[164:179]
    ds_read_b64_tr_b16 v[216:217], v240 offset:0
    ds_read_b64_tr_b16 v[218:219], v240 offset:768
    ds_read_b64_tr_b16 v[220:221], v240 offset:3072
    v_mfma_f32_32x32x16_bf16 v[180:195], v[20:23], v[196:199], v[180:195]
    ds_read_b64_tr_b16 v[222:223], v240 offset:3840
    ds_read_b64_tr_b16 v[224:225], v240 offset:6144
    ds_read_b64_tr_b16 v[226:227], v240 offset:6912
    s_waitcnt lgkmcnt(10)
    v_mfma_f32_32x32x16_bf16 v[164:179], v[24:27], v[200:203], v[164:179]
    ds_read_b64_tr_b16 v[228:229], v240 offset:9216
    ds_read_b64_tr_b16 v[230:231], v240 offset:9984
    v_mfma_f32_32x32x16_bf16 v[180:195], v[28:31], v[200:203], v[180:195]
    v_cvt_pk_bf16_f32 v132, v132, v133
    v_cvt_pk_bf16_f32 v133, v134, v135
    v_cvt_pk_bf16_f32 v134, v136, v137
    v_cvt_pk_bf16_f32 v135, v138, v139
    s_waitcnt lgkmcnt(10)
    v_mfma_f32_32x32x16_bf16 v[164:179], v[32:35], v[204:207], v[164:179]
    ds_write_b128 v245, v[132:135] offset:0
    v_cvt_pk_bf16_f32 v136, v140, v141
    v_cvt_pk_bf16_f32 v137, v142, v143
    v_cvt_pk_bf16_f32 v138, v144, v145
    v_mfma_f32_32x32x16_bf16 v[180:195], v[36:39], v[204:207], v[180:195]
    v_cvt_pk_bf16_f32 v139, v146, v147
    ds_write_b128 v245, v[136:139] offset:16384
    v_cvt_pk_bf16_f32 v140, v148, v149
    v_cvt_pk_bf16_f32 v141, v150, v151
    s_waitcnt lgkmcnt(10)
    v_mfma_f32_32x32x16_bf16 v[164:179], v[40:43], v[208:211], v[164:179]
    v_cvt_pk_bf16_f32 v142, v152, v153
    v_cvt_pk_bf16_f32 v143, v154, v155
    ds_write_b128 v245, v[140:143] offset:2048
    v_cvt_pk_bf16_f32 v144, v156, v157
    v_mfma_f32_32x32x16_bf16 v[180:195], v[44:47], v[208:211], v[180:195]
    v_cvt_pk_bf16_f32 v145, v158, v159
    v_cvt_pk_bf16_f32 v146, v160, v161
    v_cvt_pk_bf16_f32 v147, v162, v163
    ds_write_b128 v245, v[144:147] offset:18432
    s_waitcnt lgkmcnt(10)
    v_mfma_f32_32x32x16_bf16 v[100:115], v[216:219], v[16:19], v[100:115]
    v_mfma_f32_32x32x16_bf16 v[116:131], v[216:219], v[20:23], v[116:131]
    s_waitcnt lgkmcnt(8)
    v_mfma_f32_32x32x16_bf16 v[100:115], v[220:223], v[24:27], v[100:115]
    s_nop 7
    v_mfma_f32_32x32x16_bf16 v[116:131], v[220:223], v[28:31], v[116:131]
    v_cvt_pk_bf16_f32 v148, v164, v165
    v_cvt_pk_bf16_f32 v149, v166, v167
    v_cvt_pk_bf16_f32 v150, v168, v169
    v_cvt_pk_bf16_f32 v151, v170, v171
    s_waitcnt lgkmcnt(6)
    v_mfma_f32_32x32x16_bf16 v[100:115], v[224:227], v[32:35], v[100:115]
    ds_write_b128 v248, v[148:151] offset:0
    v_cvt_pk_bf16_f32 v152, v172, v173
    v_cvt_pk_bf16_f32 v153, v174, v175
    v_cvt_pk_bf16_f32 v154, v176, v177
    v_mfma_f32_32x32x16_bf16 v[116:131], v[224:227], v[36:39], v[116:131]
    v_cvt_pk_bf16_f32 v155, v178, v179
    ds_write_b128 v248, v[152:155] offset:512
    v_cvt_pk_bf16_f32 v156, v180, v181
    v_cvt_pk_bf16_f32 v157, v182, v183
    s_waitcnt lgkmcnt(6)
    v_mfma_f32_32x32x16_bf16 v[100:115], v[228:231], v[40:43], v[100:115]
    v_cvt_pk_bf16_f32 v158, v184, v185
    v_cvt_pk_bf16_f32 v159, v186, v187
    ds_write_b128 v248, v[156:159] offset:2048
    v_cvt_pk_bf16_f32 v160, v188, v189
    v_mfma_f32_32x32x16_bf16 v[116:131], v[228:231], v[44:47], v[116:131]
    v_cvt_pk_bf16_f32 v161, v190, v191
    v_cvt_pk_bf16_f32 v162, v192, v193
    v_cvt_pk_bf16_f32 v163, v194, v195
    ds_write_b128 v248, v[160:163] offset:2560
    s_cmp_lg_u32 s60, 0
    s_cbranch_scc1 L_cp_later
    buffer_store_dwordx4 v[132:135], v244, s[20:23], s58 offen offset:0 sc1
    buffer_store_dwordx4 v[136:139], v244, s[20:23], s59 offen offset:0 sc1
    buffer_store_dwordx4 v[140:143], v244, s[20:23], s58 offen offset:2048 sc1
    buffer_store_dwordx4 v[144:147], v244, s[20:23], s59 offen offset:2048 sc1
    buffer_store_dwordx4 v[148:151], v247, s[20:23], s58 offen offset:0 sc1
    buffer_store_dwordx4 v[152:155], v247, s[20:23], s58 offen offset:512 sc1
    buffer_store_dwordx4 v[156:159], v247, s[20:23], s58 offen offset:2048 sc1
    buffer_store_dwordx4 v[160:163], v247, s[20:23], s58 offen offset:2560 sc1
L_cp_later:
    s_nop 5
    v_pk_mul_f32 v[108:109], v[108:109], s[46:47]
    v_pk_mul_f32 v[110:111], v[110:111], s[46:47]
    v_pk_mul_f32 v[112:113], v[112:113], s[46:47]
    v_pk_mul_f32 v[114:115], v[114:115], s[46:47]
    v_cvt_pk_bf16_f32 v108, v108, v109
    v_cvt_pk_bf16_f32 v109, v110, v111
    v_cvt_pk_bf16_f32 v110, v112, v113
    v_cvt_pk_bf16_f32 v111, v114, v115
    ds_write_b128 v249, v[108:111] offset:0
    v_pk_mul_f32 v[124:125], v[124:125], s[46:47]
    v_pk_mul_f32 v[126:127], v[126:127], s[46:47]
    v_pk_mul_f32 v[128:129], v[128:129], s[46:47]
    v_pk_mul_f32 v[130:131], v[130:131], s[46:47]
    v_cvt_pk_bf16_f32 v124, v124, v125
    v_cvt_pk_bf16_f32 v125, v126, v127
    v_cvt_pk_bf16_f32 v126, v128, v129
    v_cvt_pk_bf16_f32 v127, v130, v131
    ds_write_b128 v249, v[124:127] offset:1024
    v_pk_mul_f32 v[100:101], v[100:101], s[46:47]
    v_pk_mul_f32 v[102:103], v[102:103], s[46:47]
    v_pk_mul_f32 v[104:105], v[104:105], s[46:47]
    v_pk_mul_f32 v[106:107], v[106:107], s[46:47]
    v_cvt_pk_bf16_f32 v8, v100, v101
    v_cvt_pk_bf16_f32 v9, v102, v103
    v_cvt_pk_bf16_f32 v10, v104, v105
    v_cvt_pk_bf16_f32 v11, v106, v107
    v_pk_mul_f32 v[116:117], v[116:117], s[46:47]
    v_pk_mul_f32 v[118:119], v[118:119], s[46:47]
    v_pk_mul_f32 v[120:121], v[120:121], s[46:47]
    v_pk_mul_f32 v[122:123], v[122:123], s[46:47]
    v_cvt_pk_bf16_f32 v12, v116, v117
    v_cvt_pk_bf16_f32 v13, v118, v119
    v_cvt_pk_bf16_f32 v14, v120, v121
    v_cvt_pk_bf16_f32 v15, v122, v123
    s_waitcnt lgkmcnt(0)
    s_barrier
L_nb_b8:
L_attn:
    ds_read_b128 v[16:19], v2
    ds_read_b128 v[20:23], v3
    ds_read_b128 v[24:27], v3 offset:512
    s_setprio 3
    s_waitcnt lgkmcnt(2)
    v_mfma_f32_32x32x16_bf16 v[36:51], v[16:19], v[8:11], 0
    s_nop 11
    s_waitcnt lgkmcnt(0)
    v_exp_f32 v36, v36
    v_exp_f32 v37, v37
    ds_read_b128 v[28:31], v3 offset:2048
    v_exp_f32 v38, v38
    v_exp_f32 v39, v39
    v_exp_f32 v40, v40
    v_exp_f32 v41, v41
    v_mfma_f32_32x32x16_bf16 v[52:67], v[16:19], v[12:15], 0
    ds_read_b128 v[16:19], v2 offset:2048
    v_exp_f32 v42, v42
    v_exp_f32 v43, v43
    v_exp_f32 v44, v44
    v_exp_f32 v45, v45
    v_exp_f32 v46, v46
    v_smfmac_f32_32x32x32_bf16 v[68:83], v[20:23], v[36:43], v5
    ds_read_b128 v[32:35], v3 offset:2560
    v_exp_f32 v47, v47
    v_exp_f32 v48, v48
    v_exp_f32 v49, v49
    v_exp_f32 v50, v50
    v_exp_f32 v51, v51
    v_exp_f32 v52, v52
    v_exp_f32 v53, v53
    v_smfmac_f32_32x32x32_bf16 v[68:83], v[24:27], v[44:51], v5
    s_waitcnt lgkmcnt(1)
    v_exp_f32 v54, v54
    v_exp_f32 v55, v55
    v_exp_f32 v56, v56
    v_exp_f32 v57, v57
    v_mfma_f32_32x32x16_bf16 v[36:51], v[16:19], v[8:11], 0
    s_cmp_lg_u32 s60, 0
    s_cbranch_scc1 L_pg_f0
    s_waitcnt vmcnt(0)
    s_lshl_b32 s45, s43, 2
    s_add_u32 s45, s45, s40
    s_lshl_b64 exec, 1, s45
    v_mov_b32 v6, 1
    buffer_store_dword v6, v242, s[28:31], 0 offen sc1
    s_mov_b64 exec, -1
L_pg_f0:
    v_exp_f32 v58, v58
    v_exp_f32 v59, v59
    v_exp_f32 v60, v60
    v_exp_f32 v61, v61
    v_exp_f32 v62, v62
    v_smfmac_f32_32x32x32_bf16 v[84:99], v[20:23], v[52:59], v5
    s_waitcnt lgkmcnt(0)
    s_cmp_lg_u32 s60, 1
    s_cbranch_scc1 L_pg_s10
    buffer_store_dwordx4 v[132:135], v244, s[20:23], s58 offen offset:0 sc1
    buffer_store_dwordx4 v[136:139], v244, s[20:23], s59 offen offset:0 sc1
    buffer_store_dwordx4 v[140:143], v244, s[20:23], s58 offen offset:2048 sc1
L_pg_s10:
    v_exp_f32 v63, v63
    v_exp_f32 v64, v64
    v_exp_f32 v65, v65
    v_exp_f32 v66, v66
    v_exp_f32 v67, v67
    v_exp_f32 v36, v36
    v_exp_f32 v37, v37
    v_smfmac_f32_32x32x32_bf16 v[84:99], v[24:27], v[60:67], v5
    ds_read_b128 v[20:23], v3 offset:4096
    v_exp_f32 v38, v38
    v_exp_f32 v39, v39
    v_exp_f32 v40, v40
    v_exp_f32 v41, v41
    v_mfma_f32_32x32x16_bf16 v[52:67], v[16:19], v[12:15], 0
    ds_read_b128 v[16:19], v2 offset:4096
    v_exp_f32 v42, v42
    v_exp_f32 v43, v43
    v_exp_f32 v44, v44
    v_exp_f32 v45, v45
    v_exp_f32 v46, v46
    v_smfmac_f32_32x32x32_bf16 v[68:83], v[28:31], v[36:43], v5
    ds_read_b128 v[24:27], v3 offset:4608
    s_cmp_lg_u32 s60, 1
    s_cbranch_scc1 L_pg_s11
    buffer_store_dwordx4 v[144:147], v244, s[20:23], s59 offen offset:2048 sc1
    buffer_store_dwordx4 v[148:151], v247, s[20:23], s58 offen offset:0 sc1
    buffer_store_dwordx4 v[152:155], v247, s[20:23], s58 offen offset:512 sc1
L_pg_s11:
    v_exp_f32 v47, v47
    v_exp_f32 v48, v48
    v_exp_f32 v49, v49
    v_exp_f32 v50, v50
    v_exp_f32 v51, v51
    v_exp_f32 v52, v52
    v_exp_f32 v53, v53
    v_smfmac_f32_32x32x32_bf16 v[68:83], v[32:35], v[44:51], v5
    s_waitcnt lgkmcnt(1)
    v_exp_f32 v54, v54
    v_exp_f32 v55, v55
    v_exp_f32 v56, v56
    v_exp_f32 v57, v57
    v_mfma_f32_32x32x16_bf16 v[36:51], v[16:19], v[8:11], 0
    v_exp_f32 v58, v58
    v_exp_f32 v59, v59
    v_exp_f32 v60, v60
    v_exp_f32 v61, v61
    v_exp_f32 v62, v62
    v_smfmac_f32_32x32x32_bf16 v[84:99], v[28:31], v[52:59], v5
    s_waitcnt lgkmcnt(0)
    s_cmp_lg_u32 s60, 1
    s_cbranch_scc1 L_pg_s12
    buffer_store_dwordx4 v[156:159], v247, s[20:23], s58 offen offset:2048 sc1
    buffer_store_dwordx4 v[160:163], v247, s[20:23], s58 offen offset:2560 sc1
L_pg_s12:
    v_exp_f32 v63, v63
    v_exp_f32 v64, v64
    v_exp_f32 v65, v65
    v_exp_f32 v66, v66
    v_exp_f32 v67, v67
    v_exp_f32 v36, v36
    v_exp_f32 v37, v37
    v_smfmac_f32_32x32x32_bf16 v[84:99], v[32:35], v[60:67], v5
    ds_read_b128 v[28:31], v3 offset:6144
    v_exp_f32 v38, v38
    v_exp_f32 v39, v39
    v_exp_f32 v40, v40
    v_exp_f32 v41, v41
    v_mfma_f32_32x32x16_bf16 v[52:67], v[16:19], v[12:15], 0
    ds_read_b128 v[16:19], v2 offset:6144
    v_exp_f32 v42, v42
    v_exp_f32 v43, v43
    v_exp_f32 v44, v44
    v_exp_f32 v45, v45
    v_exp_f32 v46, v46
    v_smfmac_f32_32x32x32_bf16 v[68:83], v[20:23], v[36:43], v5
    ds_read_b128 v[32:35], v3 offset:6656
    s_setprio 2
    v_exp_f32 v47, v47
    v_exp_f32 v48, v48
    v_exp_f32 v49, v49
    v_exp_f32 v50, v50
    v_exp_f32 v51, v51
    v_exp_f32 v52, v52
    v_exp_f32 v53, v53
    v_smfmac_f32_32x32x32_bf16 v[68:83], v[24:27], v[44:51], v5
    s_waitcnt lgkmcnt(1)
    v_exp_f32 v54, v54
    v_exp_f32 v55, v55
    v_exp_f32 v56, v56
    v_exp_f32 v57, v57
    v_mfma_f32_32x32x16_bf16 v[36:51], v[16:19], v[8:11], 0
    v_exp_f32 v58, v58
    v_exp_f32 v59, v59
    v_exp_f32 v60, v60
    v_exp_f32 v61, v61
    v_exp_f32 v62, v62
    v_smfmac_f32_32x32x32_bf16 v[84:99], v[20:23], v[52:59], v5
    s_waitcnt lgkmcnt(0)
    v_exp_f32 v63, v63
    v_exp_f32 v64, v64
    v_exp_f32 v65, v65
    v_exp_f32 v66, v66
    v_exp_f32 v67, v67
    v_exp_f32 v36, v36
    v_exp_f32 v37, v37
    v_smfmac_f32_32x32x32_bf16 v[84:99], v[24:27], v[60:67], v5
    ds_read_b128 v[20:23], v3 offset:8192
    v_exp_f32 v38, v38
    v_exp_f32 v39, v39
    v_exp_f32 v40, v40
    v_exp_f32 v41, v41
    v_mfma_f32_32x32x16_bf16 v[52:67], v[16:19], v[12:15], 0
    ds_read_b128 v[16:19], v2 offset:8192
    v_exp_f32 v42, v42
    v_exp_f32 v43, v43
    v_exp_f32 v44, v44
    v_exp_f32 v45, v45
    v_exp_f32 v46, v46
    v_smfmac_f32_32x32x32_bf16 v[68:83], v[28:31], v[36:43], v5
    ds_read_b128 v[24:27], v3 offset:8704
    v_exp_f32 v47, v47
    v_exp_f32 v48, v48
    v_exp_f32 v49, v49
    v_exp_f32 v50, v50
    v_exp_f32 v51, v51
    v_exp_f32 v52, v52
    v_exp_f32 v53, v53
    v_smfmac_f32_32x32x32_bf16 v[68:83], v[32:35], v[44:51], v5
    s_waitcnt lgkmcnt(1)
    v_exp_f32 v54, v54
    v_exp_f32 v55, v55
    v_exp_f32 v56, v56
    v_exp_f32 v57, v57
    v_mfma_f32_32x32x16_bf16 v[36:51], v[16:19], v[8:11], 0
    buffer_load_dword v241, v242, s[28:31], 0 offen sc1
    v_exp_f32 v58, v58
    v_exp_f32 v59, v59
    v_exp_f32 v60, v60
    v_exp_f32 v61, v61
    v_exp_f32 v62, v62
    v_smfmac_f32_32x32x32_bf16 v[84:99], v[28:31], v[52:59], v5
    s_waitcnt lgkmcnt(0)
    v_exp_f32 v63, v63
    v_exp_f32 v64, v64
    v_exp_f32 v65, v65
    v_exp_f32 v66, v66
    v_exp_f32 v67, v67
    v_exp_f32 v36, v36
    v_exp_f32 v37, v37
    v_smfmac_f32_32x32x32_bf16 v[84:99], v[32:35], v[60:67], v5
    ds_read_b128 v[28:31], v3 offset:10240
    v_exp_f32 v38, v38
    v_exp_f32 v39, v39
    v_exp_f32 v40, v40
    v_exp_f32 v41, v41
    v_mfma_f32_32x32x16_bf16 v[52:67], v[16:19], v[12:15], 0
    ds_read_b128 v[16:19], v2 offset:10240
    v_exp_f32 v42, v42
    v_exp_f32 v43, v43
    v_exp_f32 v44, v44
    v_exp_f32 v45, v45
    v_exp_f32 v46, v46
    v_smfmac_f32_32x32x32_bf16 v[68:83], v[20:23], v[36:43], v5
    ds_read_b128 v[32:35], v3 offset:10752
    v_exp_f32 v47, v47
    v_exp_f32 v48, v48
    v_exp_f32 v49, v49
    v_exp_f32 v50, v50
    v_exp_f32 v51, v51
    v_exp_f32 v52, v52
    v_exp_f32 v53, v53
    v_smfmac_f32_32x32x32_bf16 v[68:83], v[24:27], v[44:51], v5
    s_waitcnt lgkmcnt(1)
    v_exp_f32 v54, v54
    v_exp_f32 v55, v55
    v_exp_f32 v56, v56
    v_exp_f32 v57, v57
    v_mfma_f32_32x32x16_bf16 v[36:51], v[16:19], v[8:11], 0
    s_waitcnt vmcnt(0)
    s_cmp_lg_u32 s60, 1
    s_cbranch_scc1 L_pg_f1
    s_lshl_b32 s45, s43, 2
    s_add_u32 s45, s45, s40
    s_lshl_b64 exec, 1, s45
    v_mov_b32 v6, 1
    buffer_store_dword v6, v242, s[28:31], 0 offen sc1
    s_mov_b64 exec, -1
L_pg_f1:
    v_cmp_ne_u32 vcc, 1, v241
    s_nop 0
    s_and_b32 vcc_lo, vcc_lo, s61
    s_cbranch_scc1 L_ol_kv0
L_olr_kv0:
    s_mov_b32 m0, s51
    s_nop 0
    buffer_load_dwordx4 v1, s[20:23], s4 offen offset:0 sc1 lds
    buffer_load_dwordx4 v1, s[20:23], s4 offen offset:1024 sc1 lds
    s_mov_b32 m0, s52
    s_nop 0
    buffer_load_dwordx4 v1, s[8:11], s4 offen offset:0 sc1 lds
    buffer_load_dwordx4 v1, s[8:11], s4 offen offset:1024 sc1 lds
    s_mov_b32 s61, 0xffff
    v_exp_f32 v58, v58
    v_exp_f32 v59, v59
    v_exp_f32 v60, v60
    v_exp_f32 v61, v61
    v_exp_f32 v62, v62
    v_smfmac_f32_32x32x32_bf16 v[84:99], v[20:23], v[52:59], v5
    s_waitcnt lgkmcnt(0)
    s_setprio 1
    v_exp_f32 v63, v63
    v_exp_f32 v64, v64
    v_exp_f32 v65, v65
    v_exp_f32 v66, v66
    v_exp_f32 v67, v67
    v_exp_f32 v36, v36
    v_exp_f32 v37, v37
    v_smfmac_f32_32x32x32_bf16 v[84:99], v[24:27], v[60:67], v5
    ds_read_b128 v[20:23], v3 offset:12288
    v_exp_f32 v38, v38
    v_exp_f32 v39, v39
    v_exp_f32 v40, v40
    v_exp_f32 v41, v41
    v_mfma_f32_32x32x16_bf16 v[52:67], v[16:19], v[12:15], 0
    ds_read_b128 v[16:19], v2 offset:12288
    v_exp_f32 v42, v42
    v_exp_f32 v43, v43
    v_exp_f32 v44, v44
    v_exp_f32 v45, v45
    v_exp_f32 v46, v46
    v_smfmac_f32_32x32x32_bf16 v[68:83], v[28:31], v[36:43], v5
    ds_read_b128 v[24:27], v3 offset:12800
    v_exp_f32 v47, v47
    v_exp_f32 v48, v48
    v_exp_f32 v49, v49
    v_exp_f32 v50, v50
    v_exp_f32 v51, v51
    v_exp_f32 v52, v52
    v_exp_f32 v53, v53
    v_smfmac_f32_32x32x32_bf16 v[68:83], v[32:35], v[44:51], v5
    s_waitcnt lgkmcnt(1)
    v_exp_f32 v54, v54
    v_exp_f32 v55, v55
    v_exp_f32 v56, v56
    v_exp_f32 v57, v57
    v_mfma_f32_32x32x16_bf16 v[36:51], v[16:19], v[8:11], 0
    v_exp_f32 v58, v58
    v_exp_f32 v59, v59
    v_exp_f32 v60, v60
    v_exp_f32 v61, v61
    v_exp_f32 v62, v62
    v_smfmac_f32_32x32x32_bf16 v[84:99], v[28:31], v[52:59], v5
    s_waitcnt lgkmcnt(0)
    v_exp_f32 v63, v63
    v_exp_f32 v64, v64
    v_exp_f32 v65, v65
    v_exp_f32 v66, v66
    v_exp_f32 v67, v67
    v_exp_f32 v36, v36
    v_exp_f32 v37, v37
    v_smfmac_f32_32x32x32_bf16 v[84:99], v[32:35], v[60:67], v5
    ds_read_b128 v[28:31], v3 offset:14336
    v_exp_f32 v38, v38
    v_exp_f32 v39, v39
    v_exp_f32 v40, v40
    v_exp_f32 v41, v41
    v_mfma_f32_32x32x16_bf16 v[52:67], v[16:19], v[12:15], 0
    ds_read_b128 v[16:19], v2 offset:14336
    v_exp_f32 v42, v42
    v_exp_f32 v43, v43
    v_exp_f32 v44, v44
    v_exp_f32 v45, v45
    v_exp_f32 v46, v46
    v_smfmac_f32_32x32x32_bf16 v[68:83], v[20:23], v[36:43], v5
    ds_read_b128 v[32:35], v3 offset:14848
    s_setprio 0
    v_exp_f32 v47, v47
    v_exp_f32 v48, v48
    v_exp_f32 v49, v49
    v_exp_f32 v50, v50
    v_exp_f32 v51, v51
    v_exp_f32 v52, v52
    v_exp_f32 v53, v53
    v_smfmac_f32_32x32x32_bf16 v[68:83], v[24:27], v[44:51], v5
    s_waitcnt lgkmcnt(1)
    v_exp_f32 v54, v54
    v_exp_f32 v55, v55
    v_exp_f32 v56, v56
    v_exp_f32 v57, v57
    v_mfma_f32_32x32x16_bf16 v[36:51], v[16:19], v[8:11], 0
    v_exp_f32 v58, v58
    v_exp_f32 v59, v59
    v_exp_f32 v60, v60
    v_exp_f32 v61, v61
    v_exp_f32 v62, v62
    v_smfmac_f32_32x32x32_bf16 v[84:99], v[20:23], v[52:59], v5
    s_waitcnt lgkmcnt(0)
    v_exp_f32 v63, v63
    v_exp_f32 v64, v64
    v_exp_f32 v65, v65
    v_exp_f32 v66, v66
    v_exp_f32 v67, v67
    v_exp_f32 v36, v36
    v_exp_f32 v37, v37
    v_smfmac_f32_32x32x32_bf16 v[84:99], v[24:27], v[60:67], v5
    s_waitcnt vmcnt(0)
    s_barrier
    ds_read_b128 v[20:23], v4 offset:0
    v_exp_f32 v38, v38
    v_exp_f32 v39, v39
    v_exp_f32 v40, v40
    v_exp_f32 v41, v41
    v_mfma_f32_32x32x16_bf16 v[52:67], v[16:19], v[12:15], 0
    ds_read_b128 v[16:19], v2 offset:32768
    v_exp_f32 v42, v42
    v_exp_f32 v43, v43
    v_exp_f32 v44, v44
    v_exp_f32 v45, v45
    v_exp_f32 v46, v46
    v_smfmac_f32_32x32x32_bf16 v[68:83], v[28:31], v[36:43], v5
    ds_read_b128 v[24:27], v4 offset:512
    v_exp_f32 v47, v47
    v_exp_f32 v48, v48
    v_exp_f32 v49, v49
    v_exp_f32 v50, v50
    v_exp_f32 v51, v51
    v_exp_f32 v52, v52
    v_exp_f32 v53, v53
    v_smfmac_f32_32x32x32_bf16 v[68:83], v[32:35], v[44:51], v5
    s_waitcnt lgkmcnt(1)
    v_exp_f32 v54, v54
    v_exp_f32 v55, v55
    v_exp_f32 v56, v56
    v_exp_f32 v57, v57
    v_mfma_f32_32x32x16_bf16 v[36:51], v[16:19], v[8:11], 0
    v_exp_f32 v58, v58
    v_exp_f32 v59, v59
    v_exp_f32 v60, v60
    v_exp_f32 v61, v61
    v_exp_f32 v62, v62
    v_smfmac_f32_32x32x32_bf16 v[84:99], v[28:31], v[52:59], v5
    s_waitcnt lgkmcnt(0)
    s_setprio 3
    v_exp_f32 v63, v63
    v_exp_f32 v64, v64
    v_exp_f32 v65, v65
    v_exp_f32 v66, v66
    v_exp_f32 v67, v67
    v_exp_f32 v36, v36
    v_exp_f32 v37, v37
    v_smfmac_f32_32x32x32_bf16 v[84:99], v[32:35], v[60:67], v5
    ds_read_b128 v[28:31], v4 offset:2048
    v_exp_f32 v38, v38
    v_exp_f32 v39, v39
    v_exp_f32 v40, v40
    v_exp_f32 v41, v41
    v_mfma_f32_32x32x16_bf16 v[52:67], v[16:19], v[12:15], 0
    ds_read_b128 v[16:19], v2 offset:34816
    v_exp_f32 v42, v42
    v_exp_f32 v43, v43
    v_exp_f32 v44, v44
    v_exp_f32 v45, v45
    v_exp_f32 v46, v46
    v_smfmac_f32_32x32x32_bf16 v[68:83], v[20:23], v[36:43], v5
    ds_read_b128 v[32:35], v4 offset:2560
    v_exp_f32 v47, v47
    v_exp_f32 v48, v48
    v_exp_f32 v49, v49
    v_exp_f32 v50, v50
    v_exp_f32 v51, v51
    v_exp_f32 v52, v52
    v_exp_f32 v53, v53
    v_smfmac_f32_32x32x32_bf16 v[68:83], v[24:27], v[44:51], v5
    s_waitcnt lgkmcnt(1)
    v_exp_f32 v54, v54
    v_exp_f32 v55, v55
    v_exp_f32 v56, v56
    v_exp_f32 v57, v57
    v_mfma_f32_32x32x16_bf16 v[36:51], v[16:19], v[8:11], 0
    v_exp_f32 v58, v58
    v_exp_f32 v59, v59
    v_exp_f32 v60, v60
    v_exp_f32 v61, v61
    v_exp_f32 v62, v62
    v_smfmac_f32_32x32x32_bf16 v[84:99], v[20:23], v[52:59], v5
    s_waitcnt lgkmcnt(0)
    v_exp_f32 v63, v63
    v_exp_f32 v64, v64
    v_exp_f32 v65, v65
    v_exp_f32 v66, v66
    v_exp_f32 v67, v67
    v_exp_f32 v36, v36
    v_exp_f32 v37, v37
    v_smfmac_f32_32x32x32_bf16 v[84:99], v[24:27], v[60:67], v5
    ds_read_b128 v[20:23], v4 offset:4096
    v_exp_f32 v38, v38
    v_exp_f32 v39, v39
    v_exp_f32 v40, v40
    v_exp_f32 v41, v41
    v_mfma_f32_32x32x16_bf16 v[52:67], v[16:19], v[12:15], 0
    ds_read_b128 v[16:19], v2 offset:36864
    v_exp_f32 v42, v42
    v_exp_f32 v43, v43
    v_exp_f32 v44, v44
    v_exp_f32 v45, v45
    v_exp_f32 v46, v46
    v_smfmac_f32_32x32x32_bf16 v[68:83], v[28:31], v[36:43], v5
    ds_read_b128 v[24:27], v4 offset:4608
    v_exp_f32 v47, v47
    v_exp_f32 v48, v48
    v_exp_f32 v49, v49
    v_exp_f32 v50, v50
    v_exp_f32 v51, v51
    v_exp_f32 v52, v52
    v_exp_f32 v53, v53
    v_smfmac_f32_32x32x32_bf16 v[68:83], v[32:35], v[44:51], v5
    s_waitcnt lgkmcnt(1)
    v_exp_f32 v54, v54
    v_exp_f32 v55, v55
    v_exp_f32 v56, v56
    v_exp_f32 v57, v57
    v_mfma_f32_32x32x16_bf16 v[36:51], v[16:19], v[8:11], 0
    v_exp_f32 v58, v58
    v_exp_f32 v59, v59
    v_exp_f32 v60, v60
    v_exp_f32 v61, v61
    v_exp_f32 v62, v62
    v_smfmac_f32_32x32x32_bf16 v[84:99], v[28:31], v[52:59], v5
    s_waitcnt lgkmcnt(0)
    v_exp_f32 v63, v63
    v_exp_f32 v64, v64
    v_exp_f32 v65, v65
    v_exp_f32 v66, v66
    v_exp_f32 v67, v67
    v_exp_f32 v36, v36
    v_exp_f32 v37, v37
    v_smfmac_f32_32x32x32_bf16 v[84:99], v[32:35], v[60:67], v5
    ds_read_b128 v[28:31], v4 offset:6144
    v_exp_f32 v38, v38
    v_exp_f32 v39, v39
    v_exp_f32 v40, v40
    v_exp_f32 v41, v41
    v_mfma_f32_32x32x16_bf16 v[52:67], v[16:19], v[12:15], 0
    ds_read_b128 v[16:19], v2 offset:38912
    v_exp_f32 v42, v42
    v_exp_f32 v43, v43
    v_exp_f32 v44, v44
    v_exp_f32 v45, v45
    v_exp_f32 v46, v46
    v_smfmac_f32_32x32x32_bf16 v[68:83], v[20:23], v[36:43], v5
    ds_read_b128 v[32:35], v4 offset:6656
    s_setprio 2
    v_exp_f32 v47, v47
    v_exp_f32 v48, v48
    v_exp_f32 v49, v49
    v_exp_f32 v50, v50
    v_exp_f32 v51, v51
    v_exp_f32 v52, v52
    v_exp_f32 v53, v53
    v_smfmac_f32_32x32x32_bf16 v[68:83], v[24:27], v[44:51], v5
    s_waitcnt lgkmcnt(1)
    v_exp_f32 v54, v54
    v_exp_f32 v55, v55
    v_exp_f32 v56, v56
    v_exp_f32 v57, v57
    v_mfma_f32_32x32x16_bf16 v[36:51], v[16:19], v[8:11], 0
    buffer_load_dword v241, v242, s[28:31], 0 offen sc1
    v_exp_f32 v58, v58
    v_exp_f32 v59, v59
    v_exp_f32 v60, v60
    v_exp_f32 v61, v61
    v_exp_f32 v62, v62
    v_smfmac_f32_32x32x32_bf16 v[84:99], v[20:23], v[52:59], v5
    s_waitcnt lgkmcnt(0)
    v_exp_f32 v63, v63
    v_exp_f32 v64, v64
    v_exp_f32 v65, v65
    v_exp_f32 v66, v66
    v_exp_f32 v67, v67
    v_exp_f32 v36, v36
    v_exp_f32 v37, v37
    v_smfmac_f32_32x32x32_bf16 v[84:99], v[24:27], v[60:67], v5
    ds_read_b128 v[20:23], v4 offset:8192
    v_exp_f32 v38, v38
    v_exp_f32 v39, v39
    v_exp_f32 v40, v40
    v_exp_f32 v41, v41
    v_mfma_f32_32x32x16_bf16 v[52:67], v[16:19], v[12:15], 0
    ds_read_b128 v[16:19], v2 offset:40960
    v_exp_f32 v42, v42
    v_exp_f32 v43, v43
    v_exp_f32 v44, v44
    v_exp_f32 v45, v45
    v_exp_f32 v46, v46
    v_smfmac_f32_32x32x32_bf16 v[68:83], v[28:31], v[36:43], v5
    ds_read_b128 v[24:27], v4 offset:8704
    v_exp_f32 v47, v47
    v_exp_f32 v48, v48
    v_exp_f32 v49, v49
    v_exp_f32 v50, v50
    v_exp_f32 v51, v51
    v_exp_f32 v52, v52
    v_exp_f32 v53, v53
    v_smfmac_f32_32x32x32_bf16 v[68:83], v[32:35], v[44:51], v5
    s_waitcnt lgkmcnt(1)
    v_exp_f32 v54, v54
    v_exp_f32 v55, v55
    v_exp_f32 v56, v56
    v_exp_f32 v57, v57
    v_mfma_f32_32x32x16_bf16 v[36:51], v[16:19], v[8:11], 0
    s_waitcnt vmcnt(0)
    v_cmp_ne_u32 vcc, 1, v241
    s_nop 0
    s_and_b32 vcc_lo, vcc_lo, s61
    s_cbranch_scc1 L_ol_kv1
L_olr_kv1:
    s_mov_b32 m0, s49
    s_nop 0
    buffer_load_dwordx4 v1, s[20:23], s5 offen offset:0 sc1 lds
    buffer_load_dwordx4 v1, s[20:23], s5 offen offset:1024 sc1 lds
    s_mov_b32 m0, s50
    s_nop 0
    buffer_load_dwordx4 v1, s[8:11], s5 offen offset:0 sc1 lds
    buffer_load_dwordx4 v1, s[8:11], s5 offen offset:1024 sc1 lds
    s_mov_b32 s61, -1
    v_exp_f32 v58, v58
    v_exp_f32 v59, v59
    v_exp_f32 v60, v60
    v_exp_f32 v61, v61
    v_exp_f32 v62, v62
    v_smfmac_f32_32x32x32_bf16 v[84:99], v[28:31], v[52:59], v5
    s_waitcnt lgkmcnt(0)
    v_exp_f32 v63, v63
    v_exp_f32 v64, v64
    v_exp_f32 v65, v65
    v_exp_f32 v66, v66
    v_exp_f32 v67, v67
    v_exp_f32 v36, v36
    v_exp_f32 v37, v37
    v_smfmac_f32_32x32x32_bf16 v[84:99], v[32:35], v[60:67], v5
    ds_read_b128 v[28:31], v4 offset:10240
    v_exp_f32 v38, v38
    v_exp_f32 v39, v39
    v_exp_f32 v40, v40
    v_exp_f32 v41, v41
    v_mfma_f32_32x32x16_bf16 v[52:67], v[16:19], v[12:15], 0
    ds_read_b128 v[16:19], v2 offset:43008
    v_exp_f32 v42, v42
    v_exp_f32 v43, v43
    v_exp_f32 v44, v44
    v_exp_f32 v45, v45
    v_exp_f32 v46, v46
    v_smfmac_f32_32x32x32_bf16 v[68:83], v[20:23], v[36:43], v5
    ds_read_b128 v[32:35], v4 offset:10752
    v_exp_f32 v47, v47
    v_exp_f32 v48, v48
    v_exp_f32 v49, v49
    v_exp_f32 v50, v50
    v_exp_f32 v51, v51
    v_exp_f32 v52, v52
    v_exp_f32 v53, v53
    v_smfmac_f32_32x32x32_bf16 v[68:83], v[24:27], v[44:51], v5
    s_waitcnt lgkmcnt(1)
    v_exp_f32 v54, v54
    v_exp_f32 v55, v55
    v_exp_f32 v56, v56
    v_exp_f32 v57, v57
    v_mfma_f32_32x32x16_bf16 v[36:51], v[16:19], v[8:11], 0
    v_exp_f32 v58, v58
    v_exp_f32 v59, v59
    v_exp_f32 v60, v60
    v_exp_f32 v61, v61
    v_exp_f32 v62, v62
    v_smfmac_f32_32x32x32_bf16 v[84:99], v[20:23], v[52:59], v5
    s_waitcnt lgkmcnt(0)
    s_setprio 1
    v_exp_f32 v63, v63
    v_exp_f32 v64, v64
    v_exp_f32 v65, v65
    v_exp_f32 v66, v66
    v_exp_f32 v67, v67
    v_exp_f32 v36, v36
    v_exp_f32 v37, v37
    v_smfmac_f32_32x32x32_bf16 v[84:99], v[24:27], v[60:67], v5
    ds_read_b128 v[20:23], v4 offset:12288
    v_exp_f32 v38, v38
    v_exp_f32 v39, v39
    v_exp_f32 v40, v40
    v_exp_f32 v41, v41
    v_mfma_f32_32x32x16_bf16 v[52:67], v[16:19], v[12:15], 0
    ds_read_b128 v[16:19], v2 offset:45056
    v_exp_f32 v42, v42
    v_exp_f32 v43, v43
    v_exp_f32 v44, v44
    v_exp_f32 v45, v45
    v_exp_f32 v46, v46
    v_smfmac_f32_32x32x32_bf16 v[68:83], v[28:31], v[36:43], v5
    ds_read_b128 v[24:27], v4 offset:12800
    v_exp_f32 v47, v47
    v_exp_f32 v48, v48
    v_exp_f32 v49, v49
    v_exp_f32 v50, v50
    v_exp_f32 v51, v51
    v_exp_f32 v52, v52
    v_exp_f32 v53, v53
    v_smfmac_f32_32x32x32_bf16 v[68:83], v[32:35], v[44:51], v5
    s_waitcnt lgkmcnt(1)
    s_add_u32 m0, s53, 0
    v_exp_f32 v54, v54
    v_exp_f32 v55, v55
    v_exp_f32 v56, v56
    v_exp_f32 v57, v57
    v_mfma_f32_32x32x16_bf16 v[36:51], v[16:19], v[8:11], 0
    buffer_load_dwordx4 v243, s[16:19], s55 offen lds
    v_exp_f32 v58, v58
    v_exp_f32 v59, v59
    v_exp_f32 v60, v60
    v_exp_f32 v61, v61
    v_exp_f32 v62, v62
    v_smfmac_f32_32x32x32_bf16 v[84:99], v[28:31], v[52:59], v5
    s_waitcnt lgkmcnt(0)
    s_add_u32 s55, s55, 8192
    v_exp_f32 v63, v63
    v_exp_f32 v64, v64
    v_exp_f32 v65, v65
    v_exp_f32 v66, v66
    v_exp_f32 v67, v67
    v_exp_f32 v36, v36
    v_exp_f32 v37, v37
    v_smfmac_f32_32x32x32_bf16 v[84:99], v[32:35], v[60:67], v5
    ds_read_b128 v[28:31], v4 offset:14336
    v_exp_f32 v38, v38
    v_exp_f32 v39, v39
    v_exp_f32 v40, v40
    v_exp_f32 v41, v41
    v_mfma_f32_32x32x16_bf16 v[52:67], v[16:19], v[12:15], 0
    ds_read_b128 v[16:19], v2 offset:47104
    v_exp_f32 v42, v42
    v_exp_f32 v43, v43
    v_exp_f32 v44, v44
    v_exp_f32 v45, v45
    v_exp_f32 v46, v46
    v_smfmac_f32_32x32x32_bf16 v[68:83], v[20:23], v[36:43], v5
    ds_read_b128 v[32:35], v4 offset:14848
    s_setprio 0
    v_exp_f32 v47, v47
    v_exp_f32 v48, v48
    v_exp_f32 v49, v49
    v_exp_f32 v50, v50
    v_exp_f32 v51, v51
    v_exp_f32 v52, v52
    v_exp_f32 v53, v53
    v_smfmac_f32_32x32x32_bf16 v[68:83], v[24:27], v[44:51], v5
    s_waitcnt lgkmcnt(1)
    s_add_u32 m0, s53, 1024
    v_exp_f32 v54, v54
    v_exp_f32 v55, v55
    v_exp_f32 v56, v56
    v_exp_f32 v57, v57
    v_mfma_f32_32x32x16_bf16 v[36:51], v[16:19], v[8:11], 0
    buffer_load_dwordx4 v243, s[16:19], s55 offen lds
    v_exp_f32 v58, v58
    v_exp_f32 v59, v59
    v_exp_f32 v60, v60
    v_exp_f32 v61, v61
    v_exp_f32 v62, v62
    v_smfmac_f32_32x32x32_bf16 v[84:99], v[20:23], v[52:59], v5
    s_waitcnt lgkmcnt(0)
    s_add_u32 s55, s55, 8192
    v_exp_f32 v63, v63
    v_exp_f32 v64, v64
    v_exp_f32 v65, v65
    v_exp_f32 v66, v66
    v_exp_f32 v67, v67
    v_exp_f32 v36, v36
    v_exp_f32 v37, v37
    v_smfmac_f32_32x32x32_bf16 v[84:99], v[24:27], v[60:67], v5
    s_waitcnt vmcnt(2)
    s_barrier
    ds_read_b128 v[20:23], v3 offset:0
    v_exp_f32 v38, v38
    v_exp_f32 v39, v39
    v_exp_f32 v40, v40
    v_exp_f32 v41, v41
    v_mfma_f32_32x32x16_bf16 v[52:67], v[16:19], v[12:15], 0
    ds_read_b128 v[16:19], v2 offset:0
    v_exp_f32 v42, v42
    v_exp_f32 v43, v43
    v_exp_f32 v44, v44
    v_exp_f32 v45, v45
    v_exp_f32 v46, v46
    v_smfmac_f32_32x32x32_bf16 v[68:83], v[28:31], v[36:43], v5
    ds_read_b128 v[24:27], v3 offset:512
    s_cmp_lg_u32 s60, 2
    s_cbranch_scc1 L_pg_s20
    buffer_store_dwordx4 v[132:135], v244, s[20:23], s58 offen offset:0 sc1
    buffer_store_dwordx4 v[136:139], v244, s[20:23], s59 offen offset:0 sc1
    buffer_store_dwordx4 v[140:143], v244, s[20:23], s58 offen offset:2048 sc1
L_pg_s20:
    v_exp_f32 v47, v47
    v_exp_f32 v48, v48
    v_exp_f32 v49, v49
    v_exp_f32 v50, v50
    v_exp_f32 v51, v51
    v_exp_f32 v52, v52
    v_exp_f32 v53, v53
    v_smfmac_f32_32x32x32_bf16 v[68:83], v[32:35], v[44:51], v5
    s_waitcnt lgkmcnt(1)
    v_exp_f32 v54, v54
    v_exp_f32 v55, v55
    v_exp_f32 v56, v56
    v_exp_f32 v57, v57
    v_mfma_f32_32x32x16_bf16 v[36:51], v[16:19], v[8:11], 0
    v_exp_f32 v58, v58
    v_exp_f32 v59, v59
    v_exp_f32 v60, v60
    v_exp_f32 v61, v61
    v_exp_f32 v62, v62
    v_smfmac_f32_32x32x32_bf16 v[84:99], v[28:31], v[52:59], v5
    s_waitcnt lgkmcnt(0)
    s_cmp_lg_u32 s60, 2
    s_cbranch_scc1 L_pg_s21
    buffer_store_dwordx4 v[144:147], v244, s[20:23], s59 offen offset:2048 sc1
    buffer_store_dwordx4 v[148:151], v247, s[20:23], s58 offen offset:0 sc1
    buffer_store_dwordx4 v[152:155], v247, s[20:23], s58 offen offset:512 sc1
L_pg_s21:
    s_setprio 3
    v_exp_f32 v63, v63
    v_exp_f32 v64, v64
    v_exp_f32 v65, v65
    v_exp_f32 v66, v66
    v_exp_f32 v67, v67
    v_exp_f32 v36, v36
    v_exp_f32 v37, v37
    v_smfmac_f32_32x32x32_bf16 v[84:99], v[32:35], v[60:67], v5
    s_mov_b32 m0, s51
    ds_read_b128 v[28:31], v3 offset:2048
    v_exp_f32 v38, v38
    v_exp_f32 v39, v39
    v_exp_f32 v40, v40
    v_exp_f32 v41, v41
    v_mfma_f32_32x32x16_bf16 v[52:67], v[16:19], v[12:15], 0
    ds_read_b128 v[16:19], v2 offset:2048
    v_exp_f32 v42, v42
    v_exp_f32 v43, v43
    v_exp_f32 v44, v44
    v_exp_f32 v45, v45
    v_exp_f32 v46, v46
    v_smfmac_f32_32x32x32_bf16 v[68:83], v[20:23], v[36:43], v5
    ds_read_b128 v[32:35], v3 offset:2560
    s_cmp_lg_u32 s60, 2
    s_cbranch_scc1 L_pg_s22
    buffer_store_dwordx4 v[156:159], v247, s[20:23], s58 offen offset:2048 sc1
    buffer_store_dwordx4 v[160:163], v247, s[20:23], s58 offen offset:2560 sc1
L_pg_s22:
    v_exp_f32 v47, v47
    v_exp_f32 v48, v48
    v_exp_f32 v49, v49
    v_exp_f32 v50, v50
    v_exp_f32 v51, v51
    v_exp_f32 v52, v52
    v_exp_f32 v53, v53
    v_smfmac_f32_32x32x32_bf16 v[68:83], v[24:27], v[44:51], v5
    s_waitcnt lgkmcnt(1)
    v_exp_f32 v54, v54
    v_exp_f32 v55, v55
    v_exp_f32 v56, v56
    v_exp_f32 v57, v57
    v_mfma_f32_32x32x16_bf16 v[36:51], v[16:19], v[8:11], 0
    buffer_load_dwordx4 v1, s[20:23], s6 offen offset:0 sc1 lds
    v_exp_f32 v58, v58
    v_exp_f32 v59, v59
    v_exp_f32 v60, v60
    v_exp_f32 v61, v61
    v_exp_f32 v62, v62
    v_smfmac_f32_32x32x32_bf16 v[84:99], v[20:23], v[52:59], v5
    s_waitcnt lgkmcnt(0)
    v_exp_f32 v63, v63
    v_exp_f32 v64, v64
    v_exp_f32 v65, v65
    v_exp_f32 v66, v66
    v_exp_f32 v67, v67
    v_exp_f32 v36, v36
    v_exp_f32 v37, v37
    v_smfmac_f32_32x32x32_bf16 v[84:99], v[24:27], v[60:67], v5
    ds_read_b128 v[20:23], v3 offset:4096
    v_exp_f32 v38, v38
    v_exp_f32 v39, v39
    v_exp_f32 v40, v40
    v_exp_f32 v41, v41
    v_mfma_f32_32x32x16_bf16 v[52:67], v[16:19], v[12:15], 0
    ds_read_b128 v[16:19], v2 offset:4096
    v_exp_f32 v42, v42
    v_exp_f32 v43, v43
    v_exp_f32 v44, v44
    v_exp_f32 v45, v45
    v_exp_f32 v46, v46
    v_smfmac_f32_32x32x32_bf16 v[68:83], v[28:31], v[36:43], v5
    ds_read_b128 v[24:27], v3 offset:4608
    v_exp_f32 v47, v47
    v_exp_f32 v48, v48
    v_exp_f32 v49, v49
    v_exp_f32 v50, v50
    v_exp_f32 v51, v51
    v_exp_f32 v52, v52
    v_exp_f32 v53, v53
    v_smfmac_f32_32x32x32_bf16 v[68:83], v[32:35], v[44:51], v5
    s_waitcnt lgkmcnt(1)
    v_exp_f32 v54, v54
    v_exp_f32 v55, v55
    v_exp_f32 v56, v56
    v_exp_f32 v57, v57
    v_mfma_f32_32x32x16_bf16 v[36:51], v[16:19], v[8:11], 0
    buffer_load_dwordx4 v1, s[20:23], s6 offen offset:1024 sc1 lds
    v_exp_f32 v58, v58
    v_exp_f32 v59, v59
    v_exp_f32 v60, v60
    v_exp_f32 v61, v61
    v_exp_f32 v62, v62
    v_smfmac_f32_32x32x32_bf16 v[84:99], v[28:31], v[52:59], v5
    s_waitcnt lgkmcnt(0)
    v_exp_f32 v63, v63
    v_exp_f32 v64, v64
    v_exp_f32 v65, v65
    v_exp_f32 v66, v66
    v_exp_f32 v67, v67
    v_exp_f32 v36, v36
    v_exp_f32 v37, v37
    v_smfmac_f32_32x32x32_bf16 v[84:99], v[32:35], v[60:67], v5
    ds_read_b128 v[28:31], v3 offset:6144
    v_exp_f32 v38, v38
    v_exp_f32 v39, v39
    v_exp_f32 v40, v40
    v_exp_f32 v41, v41
    v_mfma_f32_32x32x16_bf16 v[52:67], v[16:19], v[12:15], 0
    ds_read_b128 v[16:19], v2 offset:6144
    v_exp_f32 v42, v42
    v_exp_f32 v43, v43
    v_exp_f32 v44, v44
    v_exp_f32 v45, v45
    v_exp_f32 v46, v46
    v_smfmac_f32_32x32x32_bf16 v[68:83], v[20:23], v[36:43], v5
    ds_read_b128 v[32:35], v3 offset:6656
    s_setprio 2
    v_exp_f32 v47, v47
    v_exp_f32 v48, v48
    v_exp_f32 v49, v49
    v_exp_f32 v50, v50
    v_exp_f32 v51, v51
    v_exp_f32 v52, v52
    v_exp_f32 v53, v53
    v_smfmac_f32_32x32x32_bf16 v[68:83], v[24:27], v[44:51], v5
    s_waitcnt lgkmcnt(1)
    s_mov_b32 m0, s52
    v_exp_f32 v54, v54
    v_exp_f32 v55, v55
    v_exp_f32 v56, v56
    v_exp_f32 v57, v57
    v_mfma_f32_32x32x16_bf16 v[36:51], v[16:19], v[8:11], 0
    buffer_load_dwordx4 v1, s[8:11], s6 offen offset:0 sc1 lds
    v_exp_f32 v58, v58
    v_exp_f32 v59, v59
    v_exp_f32 v60, v60
    v_exp_f32 v61, v61
    v_exp_f32 v62, v62
    v_smfmac_f32_32x32x32_bf16 v[84:99], v[20:23], v[52:59], v5
    s_waitcnt lgkmcnt(0)
    v_exp_f32 v63, v63
    v_exp_f32 v64, v64
    v_exp_f32 v65, v65
    v_exp_f32 v66, v66
    v_exp_f32 v67, v67
    v_exp_f32 v36, v36
    v_exp_f32 v37, v37
    v_smfmac_f32_32x32x32_bf16 v[84:99], v[24:27], v[60:67], v5
    ds_read_b128 v[20:23], v3 offset:8192
    v_exp_f32 v38, v38
    v_exp_f32 v39, v39
    v_exp_f32 v40, v40
    v_exp_f32 v41, v41
    v_mfma_f32_32x32x16_bf16 v[52:67], v[16:19], v[12:15], 0
    ds_read_b128 v[16:19], v2 offset:8192
    v_exp_f32 v42, v42
    v_exp_f32 v43, v43
    v_exp_f32 v44, v44
    v_exp_f32 v45, v45
    v_exp_f32 v46, v46
    v_smfmac_f32_32x32x32_bf16 v[68:83], v[28:31], v[36:43], v5
    ds_read_b128 v[24:27], v3 offset:8704
    v_exp_f32 v47, v47
    v_exp_f32 v48, v48
    v_exp_f32 v49, v49
    v_exp_f32 v50, v50
    v_exp_f32 v51, v51
    v_exp_f32 v52, v52
    v_exp_f32 v53, v53
    v_smfmac_f32_32x32x32_bf16 v[68:83], v[32:35], v[44:51], v5
    s_waitcnt lgkmcnt(1)
    v_exp_f32 v54, v54
    v_exp_f32 v55, v55
    v_exp_f32 v56, v56
    v_exp_f32 v57, v57
    v_mfma_f32_32x32x16_bf16 v[36:51], v[16:19], v[8:11], 0
    buffer_load_dwordx4 v1, s[8:11], s6 offen offset:1024 sc1 lds
    v_exp_f32 v58, v58
    v_exp_f32 v59, v59
    v_exp_f32 v60, v60
    v_exp_f32 v61, v61
    v_exp_f32 v62, v62
    v_smfmac_f32_32x32x32_bf16 v[84:99], v[28:31], v[52:59], v5
    s_waitcnt lgkmcnt(0)
    v_exp_f32 v63, v63
    v_exp_f32 v64, v64
    v_exp_f32 v65, v65
    v_exp_f32 v66, v66
    v_exp_f32 v67, v67
    v_exp_f32 v36, v36
    v_exp_f32 v37, v37
    v_smfmac_f32_32x32x32_bf16 v[84:99], v[32:35], v[60:67], v5
    ds_read_b128 v[28:31], v3 offset:10240
    v_exp_f32 v38, v38
    v_exp_f32 v39, v39
    v_exp_f32 v40, v40
    v_exp_f32 v41, v41
    v_mfma_f32_32x32x16_bf16 v[52:67], v[16:19], v[12:15], 0
    ds_read_b128 v[16:19], v2 offset:10240
    v_exp_f32 v42, v42
    v_exp_f32 v43, v43
    v_exp_f32 v44, v44
    v_exp_f32 v45, v45
    v_exp_f32 v46, v46
    v_smfmac_f32_32x32x32_bf16 v[68:83], v[20:23], v[36:43], v5
    ds_read_b128 v[32:35], v3 offset:10752
    v_exp_f32 v47, v47
    v_exp_f32 v48, v48
    v_exp_f32 v49, v49
    v_exp_f32 v50, v50
    v_exp_f32 v51, v51
    v_exp_f32 v52, v52
    v_exp_f32 v53, v53
    v_smfmac_f32_32x32x32_bf16 v[68:83], v[24:27], v[44:51], v5
    s_waitcnt lgkmcnt(1)
    v_exp_f32 v54, v54
    v_exp_f32 v55, v55
    v_exp_f32 v56, v56
    v_exp_f32 v57, v57
    v_mfma_f32_32x32x16_bf16 v[36:51], v[16:19], v[8:11], 0
    v_exp_f32 v58, v58
    v_exp_f32 v59, v59
    v_exp_f32 v60, v60
    v_exp_f32 v61, v61
    v_exp_f32 v62, v62
    v_smfmac_f32_32x32x32_bf16 v[84:99], v[20:23], v[52:59], v5
    s_waitcnt lgkmcnt(0)
    s_setprio 1
    v_exp_f32 v63, v63
    v_exp_f32 v64, v64
    v_exp_f32 v65, v65
    v_exp_f32 v66, v66
    v_exp_f32 v67, v67
    v_exp_f32 v36, v36
    v_exp_f32 v37, v37
    v_smfmac_f32_32x32x32_bf16 v[84:99], v[24:27], v[60:67], v5
    ds_read_b128 v[20:23], v3 offset:12288
    v_exp_f32 v38, v38
    v_exp_f32 v39, v39
    v_exp_f32 v40, v40
    v_exp_f32 v41, v41
    v_mfma_f32_32x32x16_bf16 v[52:67], v[16:19], v[12:15], 0
    ds_read_b128 v[16:19], v2 offset:12288
    v_exp_f32 v42, v42
    v_exp_f32 v43, v43
    v_exp_f32 v44, v44
    v_exp_f32 v45, v45
    v_exp_f32 v46, v46
    v_smfmac_f32_32x32x32_bf16 v[68:83], v[28:31], v[36:43], v5
    ds_read_b128 v[24:27], v3 offset:12800
    v_exp_f32 v47, v47
    v_exp_f32 v48, v48
    v_exp_f32 v49, v49
    v_exp_f32 v50, v50
    v_exp_f32 v51, v51
    v_exp_f32 v52, v52
    v_exp_f32 v53, v53
    v_smfmac_f32_32x32x32_bf16 v[68:83], v[32:35], v[44:51], v5
    s_waitcnt lgkmcnt(1)
    v_exp_f32 v54, v54
    v_exp_f32 v55, v55
    v_exp_f32 v56, v56
    v_exp_f32 v57, v57
    v_mfma_f32_32x32x16_bf16 v[36:51], v[16:19], v[8:11], 0
    v_exp_f32 v58, v58
    v_exp_f32 v59, v59
    v_exp_f32 v60, v60
    v_exp_f32 v61, v61
    v_exp_f32 v62, v62
    v_smfmac_f32_32x32x32_bf16 v[84:99], v[28:31], v[52:59], v5
    s_waitcnt lgkmcnt(0)
    v_exp_f32 v63, v63
    v_exp_f32 v64, v64
    v_exp_f32 v65, v65
    v_exp_f32 v66, v66
    v_exp_f32 v67, v67
    v_exp_f32 v36, v36
    v_exp_f32 v37, v37
    v_smfmac_f32_32x32x32_bf16 v[84:99], v[32:35], v[60:67], v5
    ds_read_b128 v[28:31], v3 offset:14336
    v_exp_f32 v38, v38
    v_exp_f32 v39, v39
    v_exp_f32 v40, v40
    v_exp_f32 v41, v41
    v_mfma_f32_32x32x16_bf16 v[52:67], v[16:19], v[12:15], 0
    ds_read_b128 v[16:19], v2 offset:14336
    v_exp_f32 v42, v42
    v_exp_f32 v43, v43
    v_exp_f32 v44, v44
    v_exp_f32 v45, v45
    v_exp_f32 v46, v46
    v_smfmac_f32_32x32x32_bf16 v[68:83], v[20:23], v[36:43], v5
    ds_read_b128 v[32:35], v3 offset:14848
    s_setprio 0
    v_exp_f32 v47, v47
    v_exp_f32 v48, v48
    v_exp_f32 v49, v49
    v_exp_f32 v50, v50
    v_exp_f32 v51, v51
    v_exp_f32 v52, v52
    v_exp_f32 v53, v53
    v_smfmac_f32_32x32x32_bf16 v[68:83], v[24:27], v[44:51], v5
    s_waitcnt lgkmcnt(1)
    v_exp_f32 v54, v54
    v_exp_f32 v55, v55
    v_exp_f32 v56, v56
    v_exp_f32 v57, v57
    v_mfma_f32_32x32x16_bf16 v[36:51], v[16:19], v[8:11], 0
    v_exp_f32 v58, v58
    v_exp_f32 v59, v59
    v_exp_f32 v60, v60
    v_exp_f32 v61, v61
    v_exp_f32 v62, v62
    v_smfmac_f32_32x32x32_bf16 v[84:99], v[20:23], v[52:59], v5
    s_waitcnt lgkmcnt(0)
    v_exp_f32 v63, v63
    v_exp_f32 v64, v64
    v_exp_f32 v65, v65
    v_exp_f32 v66, v66
    v_exp_f32 v67, v67
    v_exp_f32 v36, v36
    v_exp_f32 v37, v37
    v_smfmac_f32_32x32x32_bf16 v[84:99], v[24:27], v[60:67], v5
    s_waitcnt vmcnt(0)
    s_barrier
    ds_read_b128 v[20:23], v4 offset:0
    v_exp_f32 v38, v38
    v_exp_f32 v39, v39
    v_exp_f32 v40, v40
    v_exp_f32 v41, v41
    v_mfma_f32_32x32x16_bf16 v[52:67], v[16:19], v[12:15], 0
    ds_read_b128 v[16:19], v2 offset:32768
    v_exp_f32 v42, v42
    v_exp_f32 v43, v43
    v_exp_f32 v44, v44
    v_exp_f32 v45, v45
    v_exp_f32 v46, v46
    v_smfmac_f32_32x32x32_bf16 v[68:83], v[28:31], v[36:43], v5
    ds_read_b128 v[24:27], v4 offset:512
    v_exp_f32 v47, v47
    v_exp_f32 v48, v48
    v_exp_f32 v49, v49
    v_exp_f32 v50, v50
    v_exp_f32 v51, v51
    v_exp_f32 v52, v52
    v_exp_f32 v53, v53
    v_smfmac_f32_32x32x32_bf16 v[68:83], v[32:35], v[44:51], v5
    s_waitcnt lgkmcnt(1)
    v_exp_f32 v54, v54
    v_exp_f32 v55, v55
    v_exp_f32 v56, v56
    v_exp_f32 v57, v57
    v_mfma_f32_32x32x16_bf16 v[36:51], v[16:19], v[8:11], 0
    s_cmp_lg_u32 s60, 2
    s_cbranch_scc1 L_pg_f2
    s_lshl_b32 s45, s43, 2
    s_add_u32 s45, s45, s40
    s_lshl_b64 exec, 1, s45
    v_mov_b32 v6, 1
    buffer_store_dword v6, v242, s[28:31], 0 offen sc1
    s_mov_b64 exec, -1
L_pg_f2:
    v_exp_f32 v58, v58
    v_exp_f32 v59, v59
    v_exp_f32 v60, v60
    v_exp_f32 v61, v61
    v_exp_f32 v62, v62
    v_smfmac_f32_32x32x32_bf16 v[84:99], v[28:31], v[52:59], v5
    s_waitcnt lgkmcnt(0)
    s_setprio 3
    v_exp_f32 v63, v63
    v_exp_f32 v64, v64
    v_exp_f32 v65, v65
    v_exp_f32 v66, v66
    v_exp_f32 v67, v67
    v_exp_f32 v36, v36
    v_exp_f32 v37, v37
    v_smfmac_f32_32x32x32_bf16 v[84:99], v[32:35], v[60:67], v5
    ds_read_b128 v[28:31], v4 offset:2048
    v_exp_f32 v38, v38
    v_exp_f32 v39, v39
    v_exp_f32 v40, v40
    v_exp_f32 v41, v41
    v_mfma_f32_32x32x16_bf16 v[52:67], v[16:19], v[12:15], 0
    ds_read_b128 v[16:19], v2 offset:34816
    v_exp_f32 v42, v42
    v_exp_f32 v43, v43
    v_exp_f32 v44, v44
    v_exp_f32 v45, v45
    v_exp_f32 v46, v46
    v_smfmac_f32_32x32x32_bf16 v[68:83], v[20:23], v[36:43], v5
    ds_read_b128 v[32:35], v4 offset:2560
    v_exp_f32 v47, v47
    v_exp_f32 v48, v48
    v_exp_f32 v49, v49
    v_exp_f32 v50, v50
    v_exp_f32 v51, v51
    v_exp_f32 v52, v52
    v_exp_f32 v53, v53
    v_smfmac_f32_32x32x32_bf16 v[68:83], v[24:27], v[44:51], v5
    s_waitcnt lgkmcnt(1)
    v_exp_f32 v54, v54
    v_exp_f32 v55, v55
    v_exp_f32 v56, v56
    v_exp_f32 v57, v57
    v_mfma_f32_32x32x16_bf16 v[36:51], v[16:19], v[8:11], 0
    v_exp_f32 v58, v58
    v_exp_f32 v59, v59
    v_exp_f32 v60, v60
    v_exp_f32 v61, v61
    v_exp_f32 v62, v62
    v_smfmac_f32_32x32x32_bf16 v[84:99], v[20:23], v[52:59], v5
    s_waitcnt lgkmcnt(0)
    v_exp_f32 v63, v63
    v_exp_f32 v64, v64
    v_exp_f32 v65, v65
    v_exp_f32 v66, v66
    v_exp_f32 v67, v67
    v_exp_f32 v36, v36
    v_exp_f32 v37, v37
    v_smfmac_f32_32x32x32_bf16 v[84:99], v[24:27], v[60:67], v5
    ds_read_b128 v[20:23], v4 offset:4096
    v_exp_f32 v38, v38
    v_exp_f32 v39, v39
    v_exp_f32 v40, v40
    v_exp_f32 v41, v41
    v_mfma_f32_32x32x16_bf16 v[52:67], v[16:19], v[12:15], 0
    ds_read_b128 v[16:19], v2 offset:36864
    v_exp_f32 v42, v42
    v_exp_f32 v43, v43
    v_exp_f32 v44, v44
    v_exp_f32 v45, v45
    v_exp_f32 v46, v46
    v_smfmac_f32_32x32x32_bf16 v[68:83], v[28:31], v[36:43], v5
    ds_read_b128 v[24:27], v4 offset:4608
    v_exp_f32 v47, v47
    v_exp_f32 v48, v48
    v_exp_f32 v49, v49
    v_exp_f32 v50, v50
    v_exp_f32 v51, v51
    v_exp_f32 v52, v52
    v_exp_f32 v53, v53
    v_smfmac_f32_32x32x32_bf16 v[68:83], v[32:35], v[44:51], v5
    s_waitcnt lgkmcnt(1)
    v_exp_f32 v54, v54
    v_exp_f32 v55, v55
    v_exp_f32 v56, v56
    v_exp_f32 v57, v57
    v_mfma_f32_32x32x16_bf16 v[36:51], v[16:19], v[8:11], 0
    v_exp_f32 v58, v58
    v_exp_f32 v59, v59
    v_exp_f32 v60, v60
    v_exp_f32 v61, v61
    v_exp_f32 v62, v62
    v_smfmac_f32_32x32x32_bf16 v[84:99], v[28:31], v[52:59], v5
    s_waitcnt lgkmcnt(0)
    v_exp_f32 v63, v63
    v_exp_f32 v64, v64
    v_exp_f32 v65, v65
    v_exp_f32 v66, v66
    v_exp_f32 v67, v67
    v_exp_f32 v36, v36
    v_exp_f32 v37, v37
    v_smfmac_f32_32x32x32_bf16 v[84:99], v[32:35], v[60:67], v5
    ds_read_b128 v[28:31], v4 offset:6144
    v_exp_f32 v38, v38
    v_exp_f32 v39, v39
    v_exp_f32 v40, v40
    v_exp_f32 v41, v41
    v_mfma_f32_32x32x16_bf16 v[52:67], v[16:19], v[12:15], 0
    ds_read_b128 v[16:19], v2 offset:38912
    v_exp_f32 v42, v42
    v_exp_f32 v43, v43
    v_exp_f32 v44, v44
    v_exp_f32 v45, v45
    v_exp_f32 v46, v46
    v_smfmac_f32_32x32x32_bf16 v[68:83], v[20:23], v[36:43], v5
    ds_read_b128 v[32:35], v4 offset:6656
    s_setprio 2
    v_exp_f32 v47, v47
    v_exp_f32 v48, v48
    v_exp_f32 v49, v49
    v_exp_f32 v50, v50
    v_exp_f32 v51, v51
    v_exp_f32 v52, v52
    v_exp_f32 v53, v53
    v_smfmac_f32_32x32x32_bf16 v[68:83], v[24:27], v[44:51], v5
    s_waitcnt lgkmcnt(1)
    v_exp_f32 v54, v54
    v_exp_f32 v55, v55
    v_exp_f32 v56, v56
    v_exp_f32 v57, v57
    v_mfma_f32_32x32x16_bf16 v[36:51], v[16:19], v[8:11], 0
    v_exp_f32 v58, v58
    v_exp_f32 v59, v59
    v_exp_f32 v60, v60
    v_exp_f32 v61, v61
    v_exp_f32 v62, v62
    v_smfmac_f32_32x32x32_bf16 v[84:99], v[20:23], v[52:59], v5
    s_waitcnt lgkmcnt(0)
    v_exp_f32 v63, v63
    v_exp_f32 v64, v64
    v_exp_f32 v65, v65
    v_exp_f32 v66, v66
    v_exp_f32 v67, v67
    v_exp_f32 v36, v36
    v_exp_f32 v37, v37
    v_smfmac_f32_32x32x32_bf16 v[84:99], v[24:27], v[60:67], v5
    ds_read_b128 v[20:23], v4 offset:8192
    v_exp_f32 v38, v38
    v_exp_f32 v39, v39
    v_exp_f32 v40, v40
    v_exp_f32 v41, v41
    v_mfma_f32_32x32x16_bf16 v[52:67], v[16:19], v[12:15], 0
    ds_read_b128 v[16:19], v2 offset:40960
    buffer_load_dword v241, v242, s[28:31], 0 offen sc1
    v_exp_f32 v42, v42
    v_exp_f32 v43, v43
    v_exp_f32 v44, v44
    v_exp_f32 v45, v45
    v_exp_f32 v46, v46
    v_smfmac_f32_32x32x32_bf16 v[68:83], v[28:31], v[36:43], v5
    ds_read_b128 v[24:27], v4 offset:8704
    v_exp_f32 v47, v47
    v_exp_f32 v48, v48
    v_exp_f32 v49, v49
    v_exp_f32 v50, v50
    v_exp_f32 v51, v51
    v_exp_f32 v52, v52
    v_exp_f32 v53, v53
    v_smfmac_f32_32x32x32_bf16 v[68:83], v[32:35], v[44:51], v5
    s_waitcnt lgkmcnt(1)
    v_exp_f32 v54, v54
    v_exp_f32 v55, v55
    v_exp_f32 v56, v56
    v_exp_f32 v57, v57
    v_mfma_f32_32x32x16_bf16 v[36:51], v[16:19], v[8:11], 0
    v_exp_f32 v58, v58
    v_exp_f32 v59, v59
    v_exp_f32 v60, v60
    v_exp_f32 v61, v61
    v_exp_f32 v62, v62
    v_smfmac_f32_32x32x32_bf16 v[84:99], v[28:31], v[52:59], v5
    s_waitcnt lgkmcnt(0)
    v_exp_f32 v63, v63
    v_exp_f32 v64, v64
    v_exp_f32 v65, v65
    v_exp_f32 v66, v66
    v_exp_f32 v67, v67
    v_exp_f32 v36, v36
    v_exp_f32 v37, v37
    v_smfmac_f32_32x32x32_bf16 v[84:99], v[32:35], v[60:67], v5
    ds_read_b128 v[28:31], v4 offset:10240
    s_waitcnt vmcnt(0)
    v_cmp_ne_u32 vcc, 1, v241
    s_nop 0
    s_and_b32 vcc_lo, vcc_lo, s61
    s_cbranch_scc1 L_ol_kv2
L_olr_kv2:
    s_mov_b32 m0, s49
    s_nop 0
    buffer_load_dwordx4 v1, s[20:23], s7 offen offset:0 sc1 lds
    buffer_load_dwordx4 v1, s[20:23], s7 offen offset:1024 sc1 lds
    s_mov_b32 m0, s50
    s_nop 0
    buffer_load_dwordx4 v1, s[8:11], s7 offen offset:0 sc1 lds
    buffer_load_dwordx4 v1, s[8:11], s7 offen offset:1024 sc1 lds
    v_exp_f32 v38, v38
    v_exp_f32 v39, v39
    v_exp_f32 v40, v40
    v_exp_f32 v41, v41
    v_mfma_f32_32x32x16_bf16 v[52:67], v[16:19], v[12:15], 0
    ds_read_b128 v[16:19], v2 offset:43008
    v_exp_f32 v42, v42
    v_exp_f32 v43, v43
    v_exp_f32 v44, v44
    v_exp_f32 v45, v45
    v_exp_f32 v46, v46
    v_smfmac_f32_32x32x32_bf16 v[68:83], v[20:23], v[36:43], v5
    ds_read_b128 v[32:35], v4 offset:10752
    v_exp_f32 v47, v47
    v_exp_f32 v48, v48
    v_exp_f32 v49, v49
    v_exp_f32 v50, v50
    v_exp_f32 v51, v51
    v_exp_f32 v52, v52
    v_exp_f32 v53, v53
    v_smfmac_f32_32x32x32_bf16 v[68:83], v[24:27], v[44:51], v5
    s_waitcnt lgkmcnt(1)
    v_exp_f32 v54, v54
    v_exp_f32 v55, v55
    v_exp_f32 v56, v56
    v_exp_f32 v57, v57
    v_mfma_f32_32x32x16_bf16 v[36:51], v[16:19], v[8:11], 0
    v_exp_f32 v58, v58
    v_exp_f32 v59, v59
    v_exp_f32 v60, v60
    v_exp_f32 v61, v61
    v_exp_f32 v62, v62
    v_smfmac_f32_32x32x32_bf16 v[84:99], v[20:23], v[52:59], v5
    s_waitcnt lgkmcnt(0)
    s_setprio 1
    v_exp_f32 v63, v63
    v_exp_f32 v64, v64
    v_exp_f32 v65, v65
    v_exp_f32 v66, v66
    v_exp_f32 v67, v67
    v_exp_f32 v36, v36
    v_exp_f32 v37, v37
    v_smfmac_f32_32x32x32_bf16 v[84:99], v[24:27], v[60:67], v5
    ds_read_b128 v[20:23], v4 offset:12288
    v_exp_f32 v38, v38
    v_exp_f32 v39, v39
    v_exp_f32 v40, v40
    v_exp_f32 v41, v41
    v_mfma_f32_32x32x16_bf16 v[52:67], v[16:19], v[12:15], 0
    ds_read_b128 v[16:19], v2 offset:45056
    v_exp_f32 v42, v42
    v_exp_f32 v43, v43
    v_exp_f32 v44, v44
    v_exp_f32 v45, v45
    v_exp_f32 v46, v46
    v_smfmac_f32_32x32x32_bf16 v[68:83], v[28:31], v[36:43], v5
    ds_read_b128 v[24:27], v4 offset:12800
    v_exp_f32 v47, v47
    v_exp_f32 v48, v48
    v_exp_f32 v49, v49
    v_exp_f32 v50, v50
    v_exp_f32 v51, v51
    v_exp_f32 v52, v52
    v_exp_f32 v53, v53
    v_smfmac_f32_32x32x32_bf16 v[68:83], v[32:35], v[44:51], v5
    s_waitcnt lgkmcnt(1)
    s_add_u32 m0, s53, 2048
    v_exp_f32 v54, v54
    v_exp_f32 v55, v55
    v_exp_f32 v56, v56
    v_exp_f32 v57, v57
    v_mfma_f32_32x32x16_bf16 v[36:51], v[16:19], v[8:11], 0
    buffer_load_dwordx4 v243, s[16:19], s55 offen lds
    v_exp_f32 v58, v58
    v_exp_f32 v59, v59
    v_exp_f32 v60, v60
    v_exp_f32 v61, v61
    v_exp_f32 v62, v62
    v_smfmac_f32_32x32x32_bf16 v[84:99], v[28:31], v[52:59], v5
    s_waitcnt lgkmcnt(0)
    s_add_u32 s55, s55, 8192
    v_exp_f32 v63, v63
    v_exp_f32 v64, v64
    v_exp_f32 v65, v65
    v_exp_f32 v66, v66
    v_exp_f32 v67, v67
    v_exp_f32 v36, v36
    v_exp_f32 v37, v37
    v_smfmac_f32_32x32x32_bf16 v[84:99], v[32:35], v[60:67], v5
    ds_read_b128 v[28:31], v4 offset:14336
    v_exp_f32 v38, v38
    v_exp_f32 v39, v39
    v_exp_f32 v40, v40
    v_exp_f32 v41, v41
    v_mfma_f32_32x32x16_bf16 v[52:67], v[16:19], v[12:15], 0
    ds_read_b128 v[16:19], v2 offset:47104
    v_exp_f32 v42, v42
    v_exp_f32 v43, v43
    v_exp_f32 v44, v44
    v_exp_f32 v45, v45
    v_exp_f32 v46, v46
    v_smfmac_f32_32x32x32_bf16 v[68:83], v[20:23], v[36:43], v5
    ds_read_b128 v[32:35], v4 offset:14848
    s_setprio 0
    v_exp_f32 v47, v47
    v_exp_f32 v48, v48
    v_exp_f32 v49, v49
    v_exp_f32 v50, v50
    v_exp_f32 v51, v51
    v_exp_f32 v52, v52
    v_exp_f32 v53, v53
    v_smfmac_f32_32x32x32_bf16 v[68:83], v[24:27], v[44:51], v5
    s_waitcnt lgkmcnt(1)
    s_add_u32 m0, s53, 3072
    v_exp_f32 v54, v54
    v_exp_f32 v55, v55
    v_exp_f32 v56, v56
    v_exp_f32 v57, v57
    v_mfma_f32_32x32x16_bf16 v[36:51], v[16:19], v[8:11], 0
    buffer_load_dwordx4 v243, s[16:19], s55 offen lds
    v_exp_f32 v58, v58
    v_exp_f32 v59, v59
    v_exp_f32 v60, v60
    v_exp_f32 v61, v61
    v_exp_f32 v62, v62
    v_smfmac_f32_32x32x32_bf16 v[84:99], v[20:23], v[52:59], v5
    s_waitcnt lgkmcnt(0)
    s_add_u32 s55, s55, 8192
    v_exp_f32 v63, v63
    v_exp_f32 v64, v64
    v_exp_f32 v65, v65
    v_exp_f32 v66, v66
    v_exp_f32 v67, v67
    v_exp_f32 v36, v36
    v_exp_f32 v37, v37
    v_smfmac_f32_32x32x32_bf16 v[84:99], v[24:27], v[60:67], v5
    s_waitcnt vmcnt(2)
    s_barrier
    ds_read_b128 v[20:23], v3 offset:0
    v_exp_f32 v38, v38
    v_exp_f32 v39, v39
    v_exp_f32 v40, v40
    v_exp_f32 v41, v41
    v_mfma_f32_32x32x16_bf16 v[52:67], v[16:19], v[12:15], 0
    ds_read_b128 v[16:19], v2 offset:0
    v_exp_f32 v42, v42
    v_exp_f32 v43, v43
    v_exp_f32 v44, v44
    v_exp_f32 v45, v45
    v_exp_f32 v46, v46
    v_smfmac_f32_32x32x32_bf16 v[68:83], v[28:31], v[36:43], v5
    ds_read_b128 v[24:27], v3 offset:512
    v_exp_f32 v47, v47
    v_exp_f32 v48, v48
    v_exp_f32 v49, v49
    v_exp_f32 v50, v50
    v_exp_f32 v51, v51
    v_exp_f32 v52, v52
    v_exp_f32 v53, v53
    v_smfmac_f32_32x32x32_bf16 v[68:83], v[32:35], v[44:51], v5
    s_waitcnt lgkmcnt(1)
    v_exp_f32 v54, v54
    v_exp_f32 v55, v55
    v_exp_f32 v56, v56
    v_exp_f32 v57, v57
    v_mfma_f32_32x32x16_bf16 v[36:51], v[16:19], v[8:11], 0
    v_exp_f32 v58, v58
    v_exp_f32 v59, v59
    v_exp_f32 v60, v60
    v_exp_f32 v61, v61
    v_exp_f32 v62, v62
    v_smfmac_f32_32x32x32_bf16 v[84:99], v[28:31], v[52:59], v5
    s_waitcnt lgkmcnt(0)
    s_setprio 3
    v_exp_f32 v63, v63
    v_exp_f32 v64, v64
    v_exp_f32 v65, v65
    v_exp_f32 v66, v66
    v_exp_f32 v67, v67
    v_exp_f32 v36, v36
    v_exp_f32 v37, v37
    v_smfmac_f32_32x32x32_bf16 v[84:99], v[32:35], v[60:67], v5
    s_mov_b32 m0, s51
    ds_read_b128 v[28:31], v3 offset:2048
    v_exp_f32 v38, v38
    v_exp_f32 v39, v39
    v_exp_f32 v40, v40
    v_exp_f32 v41, v41
    v_mfma_f32_32x32x16_bf16 v[52:67], v[16:19], v[12:15], 0
    ds_read_b128 v[16:19], v2 offset:2048
    v_exp_f32 v42, v42
    v_exp_f32 v43, v43
    v_exp_f32 v44, v44
    v_exp_f32 v45, v45
    v_exp_f32 v46, v46
    v_smfmac_f32_32x32x32_bf16 v[68:83], v[20:23], v[36:43], v5
    ds_read_b128 v[32:35], v3 offset:2560
    v_exp_f32 v47, v47
    v_exp_f32 v48, v48
    v_exp_f32 v49, v49
    v_exp_f32 v50, v50
    v_exp_f32 v51, v51
    v_exp_f32 v52, v52
    v_exp_f32 v53, v53
    v_smfmac_f32_32x32x32_bf16 v[68:83], v[24:27], v[44:51], v5
    s_waitcnt lgkmcnt(1)
    v_exp_f32 v54, v54
    v_exp_f32 v55, v55
    v_exp_f32 v56, v56
    v_exp_f32 v57, v57
    v_mfma_f32_32x32x16_bf16 v[36:51], v[16:19], v[8:11], 0
    buffer_load_dwordx4 v1, s[20:23], s12 offen offset:0 sc1 lds
    v_exp_f32 v58, v58
    v_exp_f32 v59, v59
    v_exp_f32 v60, v60
    v_exp_f32 v61, v61
    v_exp_f32 v62, v62
    v_smfmac_f32_32x32x32_bf16 v[84:99], v[20:23], v[52:59], v5
    s_waitcnt lgkmcnt(0)
    v_exp_f32 v63, v63
    v_exp_f32 v64, v64
    v_exp_f32 v65, v65
    v_exp_f32 v66, v66
    v_exp_f32 v67, v67
    v_exp_f32 v36, v36
    v_exp_f32 v37, v37
    v_smfmac_f32_32x32x32_bf16 v[84:99], v[24:27], v[60:67], v5
    ds_read_b128 v[20:23], v3 offset:4096
    v_exp_f32 v38, v38
    v_exp_f32 v39, v39
    v_exp_f32 v40, v40
    v_exp_f32 v41, v41
    v_mfma_f32_32x32x16_bf16 v[52:67], v[16:19], v[12:15], 0
    ds_read_b128 v[16:19], v2 offset:4096
    v_exp_f32 v42, v42
    v_exp_f32 v43, v43
    v_exp_f32 v44, v44
    v_exp_f32 v45, v45
    v_exp_f32 v46, v46
    v_smfmac_f32_32x32x32_bf16 v[68:83], v[28:31], v[36:43], v5
    ds_read_b128 v[24:27], v3 offset:4608
    v_exp_f32 v47, v47
    v_exp_f32 v48, v48
    v_exp_f32 v49, v49
    v_exp_f32 v50, v50
    v_exp_f32 v51, v51
    v_exp_f32 v52, v52
    v_exp_f32 v53, v53
    v_smfmac_f32_32x32x32_bf16 v[68:83], v[32:35], v[44:51], v5
    s_waitcnt lgkmcnt(1)
    v_exp_f32 v54, v54
    v_exp_f32 v55, v55
    v_exp_f32 v56, v56
    v_exp_f32 v57, v57
    v_mfma_f32_32x32x16_bf16 v[36:51], v[16:19], v[8:11], 0
    buffer_load_dwordx4 v1, s[20:23], s12 offen offset:1024 sc1 lds
    v_exp_f32 v58, v58
    v_exp_f32 v59, v59
    v_exp_f32 v60, v60
    v_exp_f32 v61, v61
    v_exp_f32 v62, v62
    v_smfmac_f32_32x32x32_bf16 v[84:99], v[28:31], v[52:59], v5
    s_waitcnt lgkmcnt(0)
    v_exp_f32 v63, v63
    v_exp_f32 v64, v64
    v_exp_f32 v65, v65
    v_exp_f32 v66, v66
    v_exp_f32 v67, v67
    v_exp_f32 v36, v36
    v_exp_f32 v37, v37
    v_smfmac_f32_32x32x32_bf16 v[84:99], v[32:35], v[60:67], v5
    ds_read_b128 v[28:31], v3 offset:6144
    v_exp_f32 v38, v38
    v_exp_f32 v39, v39
    v_exp_f32 v40, v40
    v_exp_f32 v41, v41
    v_mfma_f32_32x32x16_bf16 v[52:67], v[16:19], v[12:15], 0
    ds_read_b128 v[16:19], v2 offset:6144
    v_exp_f32 v42, v42
    v_exp_f32 v43, v43
    v_exp_f32 v44, v44
    v_exp_f32 v45, v45
    v_exp_f32 v46, v46
    v_smfmac_f32_32x32x32_bf16 v[68:83], v[20:23], v[36:43], v5
    ds_read_b128 v[32:35], v3 offset:6656
    s_setprio 2
    v_exp_f32 v47, v47
    v_exp_f32 v48, v48
    v_exp_f32 v49, v49
    v_exp_f32 v50, v50
    v_exp_f32 v51, v51
    v_exp_f32 v52, v52
    v_exp_f32 v53, v53
    v_smfmac_f32_32x32x32_bf16 v[68:83], v[24:27], v[44:51], v5
    s_waitcnt lgkmcnt(1)
    s_mov_b32 m0, s52
    v_exp_f32 v54, v54
    v_exp_f32 v55, v55
    v_exp_f32 v56, v56
    v_exp_f32 v57, v57
    v_mfma_f32_32x32x16_bf16 v[36:51], v[16:19], v[8:11], 0
    buffer_load_dwordx4 v1, s[8:11], s12 offen offset:0 sc1 lds
    v_exp_f32 v58, v58
    v_exp_f32 v59, v59
    v_exp_f32 v60, v60
    v_exp_f32 v61, v61
    v_exp_f32 v62, v62
    v_smfmac_f32_32x32x32_bf16 v[84:99], v[20:23], v[52:59], v5
    s_waitcnt lgkmcnt(0)
    v_exp_f32 v63, v63
    v_exp_f32 v64, v64
    v_exp_f32 v65, v65
    v_exp_f32 v66, v66
    v_exp_f32 v67, v67
    v_exp_f32 v36, v36
    v_exp_f32 v37, v37
    v_smfmac_f32_32x32x32_bf16 v[84:99], v[24:27], v[60:67], v5
    ds_read_b128 v[20:23], v3 offset:8192
    v_exp_f32 v38, v38
    v_exp_f32 v39, v39
    v_exp_f32 v40, v40
    v_exp_f32 v41, v41
    v_mfma_f32_32x32x16_bf16 v[52:67], v[16:19], v[12:15], 0
    ds_read_b128 v[16:19], v2 offset:8192
    v_exp_f32 v42, v42
    v_exp_f32 v43, v43
    v_exp_f32 v44, v44
    v_exp_f32 v45, v45
    v_exp_f32 v46, v46
    v_smfmac_f32_32x32x32_bf16 v[68:83], v[28:31], v[36:43], v5
    ds_read_b128 v[24:27], v3 offset:8704
    v_exp_f32 v47, v47
    v_exp_f32 v48, v48
    v_exp_f32 v49, v49
    v_exp_f32 v50, v50
    v_exp_f32 v51, v51
    v_exp_f32 v52, v52
    v_exp_f32 v53, v53
    v_smfmac_f32_32x32x32_bf16 v[68:83], v[32:35], v[44:51], v5
    s_waitcnt lgkmcnt(1)
    v_exp_f32 v54, v54
    v_exp_f32 v55, v55
    v_exp_f32 v56, v56
    v_exp_f32 v57, v57
    v_mfma_f32_32x32x16_bf16 v[36:51], v[16:19], v[8:11], 0
    buffer_load_dwordx4 v1, s[8:11], s12 offen offset:1024 sc1 lds
    v_exp_f32 v58, v58
    v_exp_f32 v59, v59
    v_exp_f32 v60, v60
    v_exp_f32 v61, v61
    v_exp_f32 v62, v62
    v_smfmac_f32_32x32x32_bf16 v[84:99], v[28:31], v[52:59], v5
    s_waitcnt lgkmcnt(0)
    v_exp_f32 v63, v63
    v_exp_f32 v64, v64
    v_exp_f32 v65, v65
    v_exp_f32 v66, v66
    v_exp_f32 v67, v67
    v_exp_f32 v36, v36
    v_exp_f32 v37, v37
    v_smfmac_f32_32x32x32_bf16 v[84:99], v[32:35], v[60:67], v5
    ds_read_b128 v[28:31], v3 offset:10240
    v_exp_f32 v38, v38
    v_exp_f32 v39, v39
    v_exp_f32 v40, v40
    v_exp_f32 v41, v41
    v_mfma_f32_32x32x16_bf16 v[52:67], v[16:19], v[12:15], 0
    ds_read_b128 v[16:19], v2 offset:10240
    v_exp_f32 v42, v42
    v_exp_f32 v43, v43
    v_exp_f32 v44, v44
    v_exp_f32 v45, v45
    v_exp_f32 v46, v46
    v_smfmac_f32_32x32x32_bf16 v[68:83], v[20:23], v[36:43], v5
    ds_read_b128 v[32:35], v3 offset:10752
    v_exp_f32 v47, v47
    v_exp_f32 v48, v48
    v_exp_f32 v49, v49
    v_exp_f32 v50, v50
    v_exp_f32 v51, v51
    v_exp_f32 v52, v52
    v_exp_f32 v53, v53
    v_smfmac_f32_32x32x32_bf16 v[68:83], v[24:27], v[44:51], v5
    s_waitcnt lgkmcnt(1)
    s_add_u32 m0, s53, 4096
    v_exp_f32 v54, v54
    v_exp_f32 v55, v55
    v_exp_f32 v56, v56
    v_exp_f32 v57, v57
    v_mfma_f32_32x32x16_bf16 v[36:51], v[16:19], v[8:11], 0
    buffer_load_dwordx4 v243, s[16:19], s55 offen lds
    v_exp_f32 v58, v58
    v_exp_f32 v59, v59
    v_exp_f32 v60, v60
    v_exp_f32 v61, v61
    v_exp_f32 v62, v62
    v_smfmac_f32_32x32x32_bf16 v[84:99], v[20:23], v[52:59], v5
    s_waitcnt lgkmcnt(0)
    s_add_u32 s55, s55, 8192
    s_setprio 1
    v_exp_f32 v63, v63
    v_exp_f32 v64, v64
    v_exp_f32 v65, v65
    v_exp_f32 v66, v66
    v_exp_f32 v67, v67
    v_exp_f32 v36, v36
    v_exp_f32 v37, v37
    v_smfmac_f32_32x32x32_bf16 v[84:99], v[24:27], v[60:67], v5
    ds_read_b128 v[20:23], v3 offset:12288
    v_exp_f32 v38, v38
    v_exp_f32 v39, v39
    v_exp_f32 v40, v40
    v_exp_f32 v41, v41
    v_mfma_f32_32x32x16_bf16 v[52:67], v[16:19], v[12:15], 0
    ds_read_b128 v[16:19], v2 offset:12288
    v_exp_f32 v42, v42
    v_exp_f32 v43, v43
    v_exp_f32 v44, v44
    v_exp_f32 v45, v45
    v_exp_f32 v46, v46
    v_smfmac_f32_32x32x32_bf16 v[68:83], v[28:31], v[36:43], v5
    ds_read_b128 v[24:27], v3 offset:12800
    v_exp_f32 v47, v47
    v_exp_f32 v48, v48
    v_exp_f32 v49, v49
    v_exp_f32 v50, v50
    v_exp_f32 v51, v51
    v_exp_f32 v52, v52
    v_exp_f32 v53, v53
    v_smfmac_f32_32x32x32_bf16 v[68:83], v[32:35], v[44:51], v5
    s_waitcnt lgkmcnt(1)
    s_add_u32 m0, s53, 5120
    v_exp_f32 v54, v54
    v_exp_f32 v55, v55
    v_exp_f32 v56, v56
    v_exp_f32 v57, v57
    v_mfma_f32_32x32x16_bf16 v[36:51], v[16:19], v[8:11], 0
    buffer_load_dwordx4 v243, s[16:19], s55 offen lds
    v_exp_f32 v58, v58
    v_exp_f32 v59, v59
    v_exp_f32 v60, v60
    v_exp_f32 v61, v61
    v_exp_f32 v62, v62
    v_smfmac_f32_32x32x32_bf16 v[84:99], v[28:31], v[52:59], v5
    s_waitcnt lgkmcnt(0)
    s_add_u32 s55, s55, 8192
    v_exp_f32 v63, v63
    v_exp_f32 v64, v64
    v_exp_f32 v65, v65
    v_exp_f32 v66, v66
    v_exp_f32 v67, v67
    v_exp_f32 v36, v36
    v_exp_f32 v37, v37
    v_smfmac_f32_32x32x32_bf16 v[84:99], v[32:35], v[60:67], v5
    ds_read_b128 v[28:31], v3 offset:14336
    v_exp_f32 v38, v38
    v_exp_f32 v39, v39
    v_exp_f32 v40, v40
    v_exp_f32 v41, v41
    v_mfma_f32_32x32x16_bf16 v[52:67], v[16:19], v[12:15], 0
    ds_read_b128 v[16:19], v2 offset:14336
    v_exp_f32 v42, v42
    v_exp_f32 v43, v43
    v_exp_f32 v44, v44
    v_exp_f32 v45, v45
    v_exp_f32 v46, v46
    v_smfmac_f32_32x32x32_bf16 v[68:83], v[20:23], v[36:43], v5
    ds_read_b128 v[32:35], v3 offset:14848
    s_waitcnt vmcnt(2)
    buffer_store_dwordx4 v[252:255], v251, s[36:39], s1 offen sc1
    s_add_u32 s45, s1, 16384
    s_setprio 0
    v_exp_f32 v47, v47
    v_exp_f32 v48, v48
    v_exp_f32 v49, v49
    v_exp_f32 v50, v50
    v_exp_f32 v51, v51
    v_exp_f32 v52, v52
    v_exp_f32 v53, v53
    v_smfmac_f32_32x32x32_bf16 v[68:83], v[24:27], v[44:51], v5
    s_waitcnt lgkmcnt(1)
    v_exp_f32 v54, v54
    v_exp_f32 v55, v55
    v_exp_f32 v56, v56
    v_exp_f32 v57, v57
    v_mfma_f32_32x32x16_bf16 v[36:51], v[16:19], v[8:11], 0
    v_exp_f32 v58, v58
    v_exp_f32 v59, v59
    v_exp_f32 v60, v60
    v_exp_f32 v61, v61
    v_exp_f32 v62, v62
    v_smfmac_f32_32x32x32_bf16 v[84:99], v[20:23], v[52:59], v5
    s_waitcnt lgkmcnt(0)
    buffer_store_dwordx4 v[252:255], v251, s[36:39], s45 offen sc1
    v_exp_f32 v63, v63
    v_exp_f32 v64, v64
    v_exp_f32 v65, v65
    v_exp_f32 v66, v66
    v_exp_f32 v67, v67
    v_exp_f32 v36, v36
    v_exp_f32 v37, v37
    v_smfmac_f32_32x32x32_bf16 v[84:99], v[24:27], v[60:67], v5
    s_waitcnt vmcnt(4)
    s_barrier
    ds_read_b128 v[20:23], v4 offset:0
    v_exp_f32 v38, v38
    v_exp_f32 v39, v39
    v_exp_f32 v40, v40
    v_exp_f32 v41, v41
    v_mfma_f32_32x32x16_bf16 v[52:67], v[16:19], v[12:15], 0
    ds_read_b128 v[16:19], v2 offset:32768
    v_exp_f32 v42, v42
    v_exp_f32 v43, v43
    v_exp_f32 v44, v44
    v_exp_f32 v45, v45
    v_exp_f32 v46, v46
    v_smfmac_f32_32x32x32_bf16 v[68:83], v[28:31], v[36:43], v5
    ds_read_b128 v[24:27], v4 offset:512
    v_exp_f32 v47, v47
    v_exp_f32 v48, v48
    v_exp_f32 v49, v49
    v_exp_f32 v50, v50
    v_exp_f32 v51, v51
    v_exp_f32 v52, v52
    v_exp_f32 v53, v53
    v_smfmac_f32_32x32x32_bf16 v[68:83], v[32:35], v[44:51], v5
    s_waitcnt lgkmcnt(1)
    v_exp_f32 v54, v54
    v_exp_f32 v55, v55
    v_exp_f32 v56, v56
    v_exp_f32 v57, v57
    v_mfma_f32_32x32x16_bf16 v[36:51], v[16:19], v[8:11], 0
    v_exp_f32 v58, v58
    v_exp_f32 v59, v59
    v_exp_f32 v60, v60
    v_exp_f32 v61, v61
    v_exp_f32 v62, v62
    v_smfmac_f32_32x32x32_bf16 v[84:99], v[28:31], v[52:59], v5
    s_waitcnt lgkmcnt(0)
    s_setprio 3
    v_exp_f32 v63, v63
    v_exp_f32 v64, v64
    v_exp_f32 v65, v65
    v_exp_f32 v66, v66
    v_exp_f32 v67, v67
    v_exp_f32 v36, v36
    v_exp_f32 v37, v37
    v_smfmac_f32_32x32x32_bf16 v[84:99], v[32:35], v[60:67], v5
    s_mov_b32 m0, s49
    ds_read_b128 v[28:31], v4 offset:2048
    v_exp_f32 v38, v38
    v_exp_f32 v39, v39
    v_exp_f32 v40, v40
    v_exp_f32 v41, v41
    v_mfma_f32_32x32x16_bf16 v[52:67], v[16:19], v[12:15], 0
    ds_read_b128 v[16:19], v2 offset:34816
    v_exp_f32 v42, v42
    v_exp_f32 v43, v43
    v_exp_f32 v44, v44
    v_exp_f32 v45, v45
    v_exp_f32 v46, v46
    v_smfmac_f32_32x32x32_bf16 v[68:83], v[20:23], v[36:43], v5
    ds_read_b128 v[32:35], v4 offset:2560
    v_exp_f32 v47, v47
    v_exp_f32 v48, v48
    v_exp_f32 v49, v49
    v_exp_f32 v50, v50
    v_exp_f32 v51, v51
    v_exp_f32 v52, v52
    v_exp_f32 v53, v53
    v_smfmac_f32_32x32x32_bf16 v[68:83], v[24:27], v[44:51], v5
    s_waitcnt lgkmcnt(1)
    v_exp_f32 v54, v54
    v_exp_f32 v55, v55
    v_exp_f32 v56, v56
    v_exp_f32 v57, v57
    v_mfma_f32_32x32x16_bf16 v[36:51], v[16:19], v[8:11], 0
    buffer_load_dwordx4 v1, s[20:23], s13 offen offset:0 sc1 lds
    v_exp_f32 v58, v58
    v_exp_f32 v59, v59
    v_exp_f32 v60, v60
    v_exp_f32 v61, v61
    v_exp_f32 v62, v62
    v_smfmac_f32_32x32x32_bf16 v[84:99], v[20:23], v[52:59], v5
    s_waitcnt lgkmcnt(0)
    v_exp_f32 v63, v63
    v_exp_f32 v64, v64
    v_exp_f32 v65, v65
    v_exp_f32 v66, v66
    v_exp_f32 v67, v67
    v_exp_f32 v36, v36
    v_exp_f32 v37, v37
    v_smfmac_f32_32x32x32_bf16 v[84:99], v[24:27], v[60:67], v5
    ds_read_b128 v[20:23], v4 offset:4096
    v_exp_f32 v38, v38
    v_exp_f32 v39, v39
    v_exp_f32 v40, v40
    v_exp_f32 v41, v41
    v_mfma_f32_32x32x16_bf16 v[52:67], v[16:19], v[12:15], 0
    ds_read_b128 v[16:19], v2 offset:36864
    v_exp_f32 v42, v42
    v_exp_f32 v43, v43
    v_exp_f32 v44, v44
    v_exp_f32 v45, v45
    v_exp_f32 v46, v46
    v_smfmac_f32_32x32x32_bf16 v[68:83], v[28:31], v[36:43], v5
    ds_read_b128 v[24:27], v4 offset:4608
    v_exp_f32 v47, v47
    v_exp_f32 v48, v48
    v_exp_f32 v49, v49
    v_exp_f32 v50, v50
    v_exp_f32 v51, v51
    v_exp_f32 v52, v52
    v_exp_f32 v53, v53
    v_smfmac_f32_32x32x32_bf16 v[68:83], v[32:35], v[44:51], v5
    s_waitcnt lgkmcnt(1)
    v_exp_f32 v54, v54
    v_exp_f32 v55, v55
    v_exp_f32 v56, v56
    v_exp_f32 v57, v57
    v_mfma_f32_32x32x16_bf16 v[36:51], v[16:19], v[8:11], 0
    buffer_load_dwordx4 v1, s[20:23], s13 offen offset:1024 sc1 lds
    v_exp_f32 v58, v58
    v_exp_f32 v59, v59
    v_exp_f32 v60, v60
    v_exp_f32 v61, v61
    v_exp_f32 v62, v62
    v_smfmac_f32_32x32x32_bf16 v[84:99], v[28:31], v[52:59], v5
    s_waitcnt lgkmcnt(0)
    v_exp_f32 v63, v63
    v_exp_f32 v64, v64
    v_exp_f32 v65, v65
    v_exp_f32 v66, v66
    v_exp_f32 v67, v67
    v_exp_f32 v36, v36
    v_exp_f32 v37, v37
    v_smfmac_f32_32x32x32_bf16 v[84:99], v[32:35], v[60:67], v5
    ds_read_b128 v[28:31], v4 offset:6144
    v_exp_f32 v38, v38
    v_exp_f32 v39, v39
    v_exp_f32 v40, v40
    v_exp_f32 v41, v41
    v_mfma_f32_32x32x16_bf16 v[52:67], v[16:19], v[12:15], 0
    ds_read_b128 v[16:19], v2 offset:38912
    v_exp_f32 v42, v42
    v_exp_f32 v43, v43
    v_exp_f32 v44, v44
    v_exp_f32 v45, v45
    v_exp_f32 v46, v46
    v_smfmac_f32_32x32x32_bf16 v[68:83], v[20:23], v[36:43], v5
    ds_read_b128 v[32:35], v4 offset:6656
    s_setprio 2
    v_exp_f32 v47, v47
    v_exp_f32 v48, v48
    v_exp_f32 v49, v49
    v_exp_f32 v50, v50
    v_exp_f32 v51, v51
    v_exp_f32 v52, v52
    v_exp_f32 v53, v53
    v_smfmac_f32_32x32x32_bf16 v[68:83], v[24:27], v[44:51], v5
    s_waitcnt lgkmcnt(1)
    s_mov_b32 m0, s50
    v_exp_f32 v54, v54
    v_exp_f32 v55, v55
    v_exp_f32 v56, v56
    v_exp_f32 v57, v57
    v_mfma_f32_32x32x16_bf16 v[36:51], v[16:19], v[8:11], 0
    buffer_load_dwordx4 v1, s[8:11], s13 offen offset:0 sc1 lds
    v_exp_f32 v58, v58
    v_exp_f32 v59, v59
    v_exp_f32 v60, v60
    v_exp_f32 v61, v61
    v_exp_f32 v62, v62
    v_smfmac_f32_32x32x32_bf16 v[84:99], v[20:23], v[52:59], v5
    s_waitcnt lgkmcnt(0)
    v_exp_f32 v63, v63
    v_exp_f32 v64, v64
    v_exp_f32 v65, v65
    v_exp_f32 v66, v66
    v_exp_f32 v67, v67
    v_exp_f32 v36, v36
    v_exp_f32 v37, v37
    v_smfmac_f32_32x32x32_bf16 v[84:99], v[24:27], v[60:67], v5
    ds_read_b128 v[20:23], v4 offset:8192
    v_exp_f32 v38, v38
    v_exp_f32 v39, v39
    v_exp_f32 v40, v40
    v_exp_f32 v41, v41
    v_mfma_f32_32x32x16_bf16 v[52:67], v[16:19], v[12:15], 0
    ds_read_b128 v[16:19], v2 offset:40960
    v_exp_f32 v42, v42
    v_exp_f32 v43, v43
    v_exp_f32 v44, v44
    v_exp_f32 v45, v45
    v_exp_f32 v46, v46
    v_smfmac_f32_32x32x32_bf16 v[68:83], v[28:31], v[36:43], v5
    ds_read_b128 v[24:27], v4 offset:8704
    v_exp_f32 v47, v47
    v_exp_f32 v48, v48
    v_exp_f32 v49, v49
    v_exp_f32 v50, v50
    v_exp_f32 v51, v51
    v_exp_f32 v52, v52
    v_exp_f32 v53, v53
    v_smfmac_f32_32x32x32_bf16 v[68:83], v[32:35], v[44:51], v5
    s_waitcnt lgkmcnt(1)
    v_exp_f32 v54, v54
    v_exp_f32 v55, v55
    v_exp_f32 v56, v56
    v_exp_f32 v57, v57
    v_mfma_f32_32x32x16_bf16 v[36:51], v[16:19], v[8:11], 0
    buffer_load_dwordx4 v1, s[8:11], s13 offen offset:1024 sc1 lds
    v_exp_f32 v58, v58
    v_exp_f32 v59, v59
    v_exp_f32 v60, v60
    v_exp_f32 v61, v61
    v_exp_f32 v62, v62
    v_smfmac_f32_32x32x32_bf16 v[84:99], v[28:31], v[52:59], v5
    s_waitcnt lgkmcnt(0)
    v_exp_f32 v63, v63
    v_exp_f32 v64, v64
    v_exp_f32 v65, v65
    v_exp_f32 v66, v66
    v_exp_f32 v67, v67
    v_exp_f32 v36, v36
    v_exp_f32 v37, v37
    v_smfmac_f32_32x32x32_bf16 v[84:99], v[32:35], v[60:67], v5
    ds_read_b128 v[28:31], v4 offset:10240
    v_exp_f32 v38, v38
    v_exp_f32 v39, v39
    v_exp_f32 v40, v40
    v_exp_f32 v41, v41
    v_mfma_f32_32x32x16_bf16 v[52:67], v[16:19], v[12:15], 0
    ds_read_b128 v[16:19], v2 offset:43008
    v_exp_f32 v42, v42
    v_exp_f32 v43, v43
    v_exp_f32 v44, v44
    v_exp_f32 v45, v45
    v_exp_f32 v46, v46
    v_smfmac_f32_32x32x32_bf16 v[68:83], v[20:23], v[36:43], v5
    ds_read_b128 v[32:35], v4 offset:10752
    v_exp_f32 v47, v47
    v_exp_f32 v48, v48
    v_exp_f32 v49, v49
    v_exp_f32 v50, v50
    v_exp_f32 v51, v51
    v_exp_f32 v52, v52
    v_exp_f32 v53, v53
    v_smfmac_f32_32x32x32_bf16 v[68:83], v[24:27], v[44:51], v5
    s_waitcnt lgkmcnt(1)
    s_add_u32 m0, s53, 6144
    v_exp_f32 v54, v54
    v_exp_f32 v55, v55
    v_exp_f32 v56, v56
    v_exp_f32 v57, v57
    v_mfma_f32_32x32x16_bf16 v[36:51], v[16:19], v[8:11], 0
    buffer_load_dwordx4 v243, s[16:19], s55 offen lds
    v_exp_f32 v58, v58
    v_exp_f32 v59, v59
    v_exp_f32 v60, v60
    v_exp_f32 v61, v61
    v_exp_f32 v62, v62
    v_smfmac_f32_32x32x32_bf16 v[84:99], v[20:23], v[52:59], v5
    s_waitcnt lgkmcnt(0)
    s_add_u32 s55, s55, 8192
    s_setprio 1
    v_exp_f32 v63, v63
    v_exp_f32 v64, v64
    v_exp_f32 v65, v65
    v_exp_f32 v66, v66
    v_exp_f32 v67, v67
    v_exp_f32 v36, v36
    v_exp_f32 v37, v37
    v_smfmac_f32_32x32x32_bf16 v[84:99], v[24:27], v[60:67], v5
    ds_read_b128 v[20:23], v4 offset:12288
    v_exp_f32 v38, v38
    v_exp_f32 v39, v39
    v_exp_f32 v40, v40
    v_exp_f32 v41, v41
    v_mfma_f32_32x32x16_bf16 v[52:67], v[16:19], v[12:15], 0
    ds_read_b128 v[16:19], v2 offset:45056
    v_exp_f32 v42, v42
    v_exp_f32 v43, v43
    v_exp_f32 v44, v44
    v_exp_f32 v45, v45
    v_exp_f32 v46, v46
    v_smfmac_f32_32x32x32_bf16 v[68:83], v[28:31], v[36:43], v5
    ds_read_b128 v[24:27], v4 offset:12800
    v_exp_f32 v47, v47
    v_exp_f32 v48, v48
    v_exp_f32 v49, v49
    v_exp_f32 v50, v50
    v_exp_f32 v51, v51
    v_exp_f32 v52, v52
    v_exp_f32 v53, v53
    v_smfmac_f32_32x32x32_bf16 v[68:83], v[32:35], v[44:51], v5
    s_waitcnt lgkmcnt(1)
    s_add_u32 m0, s53, 7168
    v_exp_f32 v54, v54
    v_exp_f32 v55, v55
    v_exp_f32 v56, v56
    v_exp_f32 v57, v57
    v_mfma_f32_32x32x16_bf16 v[36:51], v[16:19], v[8:11], 0
    buffer_load_dwordx4 v243, s[16:19], s55 offen lds
    v_exp_f32 v58, v58
    v_exp_f32 v59, v59
    v_exp_f32 v60, v60
    v_exp_f32 v61, v61
    v_exp_f32 v62, v62
    v_smfmac_f32_32x32x32_bf16 v[84:99], v[28:31], v[52:59], v5
    s_waitcnt lgkmcnt(0)
    s_add_u32 s55, s55, 8192
    v_exp_f32 v63, v63
    v_exp_f32 v64, v64
    v_exp_f32 v65, v65
    v_exp_f32 v66, v66
    v_exp_f32 v67, v67
    v_exp_f32 v36, v36
    v_exp_f32 v37, v37
    v_smfmac_f32_32x32x32_bf16 v[84:99], v[32:35], v[60:67], v5
    ds_read_b128 v[28:31], v4 offset:14336
    v_exp_f32 v38, v38
    v_exp_f32 v39, v39
    v_exp_f32 v40, v40
    v_exp_f32 v41, v41
    v_mfma_f32_32x32x16_bf16 v[52:67], v[16:19], v[12:15], 0
    ds_read_b128 v[16:19], v2 offset:47104
    v_exp_f32 v42, v42
    v_exp_f32 v43, v43
    v_exp_f32 v44, v44
    v_exp_f32 v45, v45
    v_exp_f32 v46, v46
    v_smfmac_f32_32x32x32_bf16 v[68:83], v[20:23], v[36:43], v5
    ds_read_b128 v[32:35], v4 offset:14848
    s_waitcnt vmcnt(2)
    buffer_store_dwordx4 v[252:255], v1, s[24:27], s62 offen sc1
    s_setprio 0
    v_exp_f32 v47, v47
    v_exp_f32 v48, v48
    v_exp_f32 v49, v49
    v_exp_f32 v50, v50
    v_exp_f32 v51, v51
    v_exp_f32 v52, v52
    v_exp_f32 v53, v53
    v_smfmac_f32_32x32x32_bf16 v[68:83], v[24:27], v[44:51], v5
    s_waitcnt lgkmcnt(1)
    v_exp_f32 v54, v54
    v_exp_f32 v55, v55
    v_exp_f32 v56, v56
    v_exp_f32 v57, v57
    v_mfma_f32_32x32x16_bf16 v[36:51], v[16:19], v[8:11], 0
    v_exp_f32 v58, v58
    v_exp_f32 v59, v59
    v_exp_f32 v60, v60
    v_exp_f32 v61, v61
    v_exp_f32 v62, v62
    v_smfmac_f32_32x32x32_bf16 v[84:99], v[20:23], v[52:59], v5
    s_waitcnt lgkmcnt(0)
    buffer_store_dwordx4 v[252:255], v1, s[24:27], s63 offen sc1
    v_exp_f32 v63, v63
    v_exp_f32 v64, v64
    v_exp_f32 v65, v65
    v_exp_f32 v66, v66
    v_exp_f32 v67, v67
    v_exp_f32 v36, v36
    v_exp_f32 v37, v37
    v_smfmac_f32_32x32x32_bf16 v[84:99], v[24:27], v[60:67], v5
    s_waitcnt vmcnt(4)
    s_barrier
    ds_read_b128 v[20:23], v3 offset:0
    v_exp_f32 v38, v38
    v_exp_f32 v39, v39
    v_exp_f32 v40, v40
    v_exp_f32 v41, v41
    v_mfma_f32_32x32x16_bf16 v[52:67], v[16:19], v[12:15], 0
    ds_read_b128 v[16:19], v2 offset:0
    v_exp_f32 v42, v42
    v_exp_f32 v43, v43
    v_exp_f32 v44, v44
    v_exp_f32 v45, v45
    v_exp_f32 v46, v46
    v_smfmac_f32_32x32x32_bf16 v[68:83], v[28:31], v[36:43], v5
    ds_read_b128 v[24:27], v3 offset:512
    v_exp_f32 v47, v47
    v_exp_f32 v48, v48
    v_exp_f32 v49, v49
    v_exp_f32 v50, v50
    v_exp_f32 v51, v51
    v_exp_f32 v52, v52
    v_exp_f32 v53, v53
    v_smfmac_f32_32x32x32_bf16 v[68:83], v[32:35], v[44:51], v5
    s_waitcnt lgkmcnt(1)
    v_exp_f32 v54, v54
    v_exp_f32 v55, v55
    v_exp_f32 v56, v56
    v_exp_f32 v57, v57
    v_mfma_f32_32x32x16_bf16 v[36:51], v[16:19], v[8:11], 0
    v_exp_f32 v58, v58
    v_exp_f32 v59, v59
    v_exp_f32 v60, v60
    v_exp_f32 v61, v61
    v_exp_f32 v62, v62
    v_smfmac_f32_32x32x32_bf16 v[84:99], v[28:31], v[52:59], v5
    s_waitcnt lgkmcnt(0)
    s_setprio 3
    v_exp_f32 v63, v63
    v_exp_f32 v64, v64
    v_exp_f32 v65, v65
    v_exp_f32 v66, v66
    v_exp_f32 v67, v67
    v_exp_f32 v36, v36
    v_exp_f32 v37, v37
    v_smfmac_f32_32x32x32_bf16 v[84:99], v[32:35], v[60:67], v5
    s_mov_b32 m0, s51
    ds_read_b128 v[28:31], v3 offset:2048
    v_exp_f32 v38, v38
    v_exp_f32 v39, v39
    v_exp_f32 v40, v40
    v_exp_f32 v41, v41
    v_mfma_f32_32x32x16_bf16 v[52:67], v[16:19], v[12:15], 0
    ds_read_b128 v[16:19], v2 offset:2048
    v_exp_f32 v42, v42
    v_exp_f32 v43, v43
    v_exp_f32 v44, v44
    v_exp_f32 v45, v45
    v_exp_f32 v46, v46
    v_smfmac_f32_32x32x32_bf16 v[68:83], v[20:23], v[36:43], v5
    ds_read_b128 v[32:35], v3 offset:2560
    v_exp_f32 v47, v47
    v_exp_f32 v48, v48
    v_exp_f32 v49, v49
    v_exp_f32 v50, v50
    v_exp_f32 v51, v51
    v_exp_f32 v52, v52
    v_exp_f32 v53, v53
    v_smfmac_f32_32x32x32_bf16 v[68:83], v[24:27], v[44:51], v5
    s_waitcnt lgkmcnt(1)
    v_exp_f32 v54, v54
    v_exp_f32 v55, v55
    v_exp_f32 v56, v56
    v_exp_f32 v57, v57
    v_mfma_f32_32x32x16_bf16 v[36:51], v[16:19], v[8:11], 0
    buffer_load_dwordx4 v1, s[20:23], s14 offen offset:0 sc1 lds
    v_exp_f32 v58, v58
    v_exp_f32 v59, v59
    v_exp_f32 v60, v60
    v_exp_f32 v61, v61
    v_exp_f32 v62, v62
    v_smfmac_f32_32x32x32_bf16 v[84:99], v[20:23], v[52:59], v5
    s_waitcnt lgkmcnt(0)
    v_exp_f32 v63, v63
    v_exp_f32 v64, v64
    v_exp_f32 v65, v65
    v_exp_f32 v66, v66
    v_exp_f32 v67, v67
    v_exp_f32 v36, v36
    v_exp_f32 v37, v37
    v_smfmac_f32_32x32x32_bf16 v[84:99], v[24:27], v[60:67], v5
    ds_read_b128 v[20:23], v3 offset:4096
    v_exp_f32 v38, v38
    v_exp_f32 v39, v39
    v_exp_f32 v40, v40
    v_exp_f32 v41, v41
    v_mfma_f32_32x32x16_bf16 v[52:67], v[16:19], v[12:15], 0
    ds_read_b128 v[16:19], v2 offset:4096
    v_exp_f32 v42, v42
    v_exp_f32 v43, v43
    v_exp_f32 v44, v44
    v_exp_f32 v45, v45
    v_exp_f32 v46, v46
    v_smfmac_f32_32x32x32_bf16 v[68:83], v[28:31], v[36:43], v5
    ds_read_b128 v[24:27], v3 offset:4608
    v_exp_f32 v47, v47
    v_exp_f32 v48, v48
    v_exp_f32 v49, v49
    v_exp_f32 v50, v50
    v_exp_f32 v51, v51
    v_exp_f32 v52, v52
    v_exp_f32 v53, v53
    v_smfmac_f32_32x32x32_bf16 v[68:83], v[32:35], v[44:51], v5
    s_waitcnt lgkmcnt(1)
    v_exp_f32 v54, v54
    v_exp_f32 v55, v55
    v_exp_f32 v56, v56
    v_exp_f32 v57, v57
    v_mfma_f32_32x32x16_bf16 v[36:51], v[16:19], v[8:11], 0
    buffer_load_dwordx4 v1, s[20:23], s14 offen offset:1024 sc1 lds
    v_exp_f32 v58, v58
    v_exp_f32 v59, v59
    v_exp_f32 v60, v60
    v_exp_f32 v61, v61
    v_exp_f32 v62, v62
    v_smfmac_f32_32x32x32_bf16 v[84:99], v[28:31], v[52:59], v5
    s_waitcnt lgkmcnt(0)
    v_exp_f32 v63, v63
    v_exp_f32 v64, v64
    v_exp_f32 v65, v65
    v_exp_f32 v66, v66
    v_exp_f32 v67, v67
    v_exp_f32 v36, v36
    v_exp_f32 v37, v37
    v_smfmac_f32_32x32x32_bf16 v[84:99], v[32:35], v[60:67], v5
    ds_read_b128 v[28:31], v3 offset:6144
    v_exp_f32 v38, v38
    v_exp_f32 v39, v39
    v_exp_f32 v40, v40
    v_exp_f32 v41, v41
    v_mfma_f32_32x32x16_bf16 v[52:67], v[16:19], v[12:15], 0
    ds_read_b128 v[16:19], v2 offset:6144
    v_exp_f32 v42, v42
    v_exp_f32 v43, v43
    v_exp_f32 v44, v44
    v_exp_f32 v45, v45
    v_exp_f32 v46, v46
    v_smfmac_f32_32x32x32_bf16 v[68:83], v[20:23], v[36:43], v5
    ds_read_b128 v[32:35], v3 offset:6656
    s_setprio 2
    v_exp_f32 v47, v47
    v_exp_f32 v48, v48
    v_exp_f32 v49, v49
    v_exp_f32 v50, v50
    v_exp_f32 v51, v51
    v_exp_f32 v52, v52
    v_exp_f32 v53, v53
    v_smfmac_f32_32x32x32_bf16 v[68:83], v[24:27], v[44:51], v5
    s_waitcnt lgkmcnt(1)
    s_mov_b32 m0, s52
    v_exp_f32 v54, v54
    v_exp_f32 v55, v55
    v_exp_f32 v56, v56
    v_exp_f32 v57, v57
    v_mfma_f32_32x32x16_bf16 v[36:51], v[16:19], v[8:11], 0
    buffer_load_dwordx4 v1, s[8:11], s14 offen offset:0 sc1 lds
    v_exp_f32 v58, v58
    v_exp_f32 v59, v59
    v_exp_f32 v60, v60
    v_exp_f32 v61, v61
    v_exp_f32 v62, v62
    v_smfmac_f32_32x32x32_bf16 v[84:99], v[20:23], v[52:59], v5
    s_waitcnt lgkmcnt(0)
    v_exp_f32 v63, v63
    v_exp_f32 v64, v64
    v_exp_f32 v65, v65
    v_exp_f32 v66, v66
    v_exp_f32 v67, v67
    v_exp_f32 v36, v36
    v_exp_f32 v37, v37
    v_smfmac_f32_32x32x32_bf16 v[84:99], v[24:27], v[60:67], v5
    ds_read_b128 v[20:23], v3 offset:8192
    v_exp_f32 v38, v38
    v_exp_f32 v39, v39
    v_exp_f32 v40, v40
    v_exp_f32 v41, v41
    v_mfma_f32_32x32x16_bf16 v[52:67], v[16:19], v[12:15], 0
    ds_read_b128 v[16:19], v2 offset:8192
    v_exp_f32 v42, v42
    v_exp_f32 v43, v43
    v_exp_f32 v44, v44
    v_exp_f32 v45, v45
    v_exp_f32 v46, v46
    v_smfmac_f32_32x32x32_bf16 v[68:83], v[28:31], v[36:43], v5
    ds_read_b128 v[24:27], v3 offset:8704
    v_exp_f32 v47, v47
    v_exp_f32 v48, v48
    v_exp_f32 v49, v49
    v_exp_f32 v50, v50
    v_exp_f32 v51, v51
    v_exp_f32 v52, v52
    v_exp_f32 v53, v53
    v_smfmac_f32_32x32x32_bf16 v[68:83], v[32:35], v[44:51], v5
    s_waitcnt lgkmcnt(1)
    v_exp_f32 v54, v54
    v_exp_f32 v55, v55
    v_exp_f32 v56, v56
    v_exp_f32 v57, v57
    v_mfma_f32_32x32x16_bf16 v[36:51], v[16:19], v[8:11], 0
    buffer_load_dwordx4 v1, s[8:11], s14 offen offset:1024 sc1 lds
    v_exp_f32 v58, v58
    v_exp_f32 v59, v59
    v_exp_f32 v60, v60
    v_exp_f32 v61, v61
    v_exp_f32 v62, v62
    v_smfmac_f32_32x32x32_bf16 v[84:99], v[28:31], v[52:59], v5
    s_waitcnt lgkmcnt(0)
    v_exp_f32 v63, v63
    v_exp_f32 v64, v64
    v_exp_f32 v65, v65
    v_exp_f32 v66, v66
    v_exp_f32 v67, v67
    v_exp_f32 v36, v36
    v_exp_f32 v37, v37
    v_smfmac_f32_32x32x32_bf16 v[84:99], v[32:35], v[60:67], v5
    ds_read_b128 v[28:31], v3 offset:10240
    v_exp_f32 v38, v38
    v_exp_f32 v39, v39
    v_exp_f32 v40, v40
    v_exp_f32 v41, v41
    v_mfma_f32_32x32x16_bf16 v[52:67], v[16:19], v[12:15], 0
    ds_read_b128 v[16:19], v2 offset:10240
    v_exp_f32 v42, v42
    v_exp_f32 v43, v43
    v_exp_f32 v44, v44
    v_exp_f32 v45, v45
    v_exp_f32 v46, v46
    v_smfmac_f32_32x32x32_bf16 v[68:83], v[20:23], v[36:43], v5
    ds_read_b128 v[32:35], v3 offset:10752
    v_exp_f32 v47, v47
    v_exp_f32 v48, v48
    v_exp_f32 v49, v49
    v_exp_f32 v50, v50
    v_exp_f32 v51, v51
    v_exp_f32 v52, v52
    v_exp_f32 v53, v53
    v_smfmac_f32_32x32x32_bf16 v[68:83], v[24:27], v[44:51], v5
    s_waitcnt lgkmcnt(1)
    v_exp_f32 v54, v54
    v_exp_f32 v55, v55
    v_exp_f32 v56, v56
    v_exp_f32 v57, v57
    v_mfma_f32_32x32x16_bf16 v[36:51], v[16:19], v[8:11], 0
    v_exp_f32 v58, v58
    v_exp_f32 v59, v59
    v_exp_f32 v60, v60
    v_exp_f32 v61, v61
    v_exp_f32 v62, v62
    v_smfmac_f32_32x32x32_bf16 v[84:99], v[20:23], v[52:59], v5
    s_waitcnt lgkmcnt(0)
    s_setprio 1
    v_exp_f32 v63, v63
    v_exp_f32 v64, v64
    v_exp_f32 v65, v65
    v_exp_f32 v66, v66
    v_exp_f32 v67, v67
    v_exp_f32 v36, v36
    v_exp_f32 v37, v37
    v_smfmac_f32_32x32x32_bf16 v[84:99], v[24:27], v[60:67], v5
    ds_read_b128 v[20:23], v3 offset:12288
    v_exp_f32 v38, v38
    v_exp_f32 v39, v39
    v_exp_f32 v40, v40
    v_exp_f32 v41, v41
    v_mfma_f32_32x32x16_bf16 v[52:67], v[16:19], v[12:15], 0
    ds_read_b128 v[16:19], v2 offset:12288
    v_exp_f32 v42, v42
    v_exp_f32 v43, v43
    v_exp_f32 v44, v44
    v_exp_f32 v45, v45
    v_exp_f32 v46, v46
    v_smfmac_f32_32x32x32_bf16 v[68:83], v[28:31], v[36:43], v5
    ds_read_b128 v[24:27], v3 offset:12800
    v_exp_f32 v47, v47
    v_exp_f32 v48, v48
    v_exp_f32 v49, v49
    v_exp_f32 v50, v50
    v_exp_f32 v51, v51
    v_exp_f32 v52, v52
    v_exp_f32 v53, v53
    v_smfmac_f32_32x32x32_bf16 v[68:83], v[32:35], v[44:51], v5
    s_waitcnt lgkmcnt(1)
    v_exp_f32 v54, v54
    v_exp_f32 v55, v55
    v_exp_f32 v56, v56
    v_exp_f32 v57, v57
    v_mfma_f32_32x32x16_bf16 v[36:51], v[16:19], v[8:11], 0
    v_exp_f32 v58, v58
    v_exp_f32 v59, v59
    v_exp_f32 v60, v60
    v_exp_f32 v61, v61
    v_exp_f32 v62, v62
    v_smfmac_f32_32x32x32_bf16 v[84:99], v[28:31], v[52:59], v5
    s_waitcnt lgkmcnt(0)
    v_exp_f32 v63, v63
    v_exp_f32 v64, v64
    v_exp_f32 v65, v65
    v_exp_f32 v66, v66
    v_exp_f32 v67, v67
    v_exp_f32 v36, v36
    v_exp_f32 v37, v37
    v_smfmac_f32_32x32x32_bf16 v[84:99], v[32:35], v[60:67], v5
    ds_read_b128 v[28:31], v3 offset:14336
    v_exp_f32 v38, v38
    v_exp_f32 v39, v39
    v_exp_f32 v40, v40
    v_exp_f32 v41, v41
    v_mfma_f32_32x32x16_bf16 v[52:67], v[16:19], v[12:15], 0
    ds_read_b128 v[16:19], v2 offset:14336
    v_exp_f32 v42, v42
    v_exp_f32 v43, v43
    v_exp_f32 v44, v44
    v_exp_f32 v45, v45
    v_exp_f32 v46, v46
    v_smfmac_f32_32x32x32_bf16 v[68:83], v[20:23], v[36:43], v5
    ds_read_b128 v[32:35], v3 offset:14848
    s_setprio 0
    v_exp_f32 v47, v47
    v_exp_f32 v48, v48
    v_exp_f32 v49, v49
    v_exp_f32 v50, v50
    v_exp_f32 v51, v51
    v_exp_f32 v52, v52
    v_exp_f32 v53, v53
    v_smfmac_f32_32x32x32_bf16 v[68:83], v[24:27], v[44:51], v5
    s_waitcnt lgkmcnt(1)
    v_exp_f32 v54, v54
    v_exp_f32 v55, v55
    v_exp_f32 v56, v56
    v_exp_f32 v57, v57
    v_mfma_f32_32x32x16_bf16 v[36:51], v[16:19], v[8:11], 0
    v_exp_f32 v58, v58
    v_exp_f32 v59, v59
    v_exp_f32 v60, v60
    v_exp_f32 v61, v61
    v_exp_f32 v62, v62
    v_smfmac_f32_32x32x32_bf16 v[84:99], v[20:23], v[52:59], v5
    s_waitcnt lgkmcnt(0)
    v_exp_f32 v63, v63
    v_exp_f32 v64, v64
    v_exp_f32 v65, v65
    v_exp_f32 v66, v66
    v_exp_f32 v67, v67
    v_exp_f32 v36, v36
    v_exp_f32 v37, v37
    v_smfmac_f32_32x32x32_bf16 v[84:99], v[24:27], v[60:67], v5
    s_waitcnt vmcnt(0)
    s_barrier
    ds_read_b128 v[20:23], v4 offset:0
    v_exp_f32 v38, v38
    v_exp_f32 v39, v39
    v_exp_f32 v40, v40
    v_exp_f32 v41, v41
    v_mfma_f32_32x32x16_bf16 v[52:67], v[16:19], v[12:15], 0
    ds_read_b128 v[16:19], v2 offset:32768
    v_exp_f32 v42, v42
    v_exp_f32 v43, v43
    v_exp_f32 v44, v44
    v_exp_f32 v45, v45
    v_exp_f32 v46, v46
    v_smfmac_f32_32x32x32_bf16 v[68:83], v[28:31], v[36:43], v5
    ds_read_b128 v[24:27], v4 offset:512
    v_exp_f32 v47, v47
    v_exp_f32 v48, v48
    v_exp_f32 v49, v49
    v_exp_f32 v50, v50
    v_exp_f32 v51, v51
    v_exp_f32 v52, v52
    v_exp_f32 v53, v53
    v_smfmac_f32_32x32x32_bf16 v[68:83], v[32:35], v[44:51], v5
    s_waitcnt lgkmcnt(1)
    v_exp_f32 v54, v54
    v_exp_f32 v55, v55
    v_exp_f32 v56, v56
    v_exp_f32 v57, v57
    v_mfma_f32_32x32x16_bf16 v[36:51], v[16:19], v[8:11], 0
    v_exp_f32 v58, v58
    v_exp_f32 v59, v59
    v_exp_f32 v60, v60
    v_exp_f32 v61, v61
    v_exp_f32 v62, v62
    v_smfmac_f32_32x32x32_bf16 v[84:99], v[28:31], v[52:59], v5
    s_waitcnt lgkmcnt(0)
    s_setprio 3
    v_exp_f32 v63, v63
    v_exp_f32 v64, v64
    v_exp_f32 v65, v65
    v_exp_f32 v66, v66
    v_exp_f32 v67, v67
    v_exp_f32 v36, v36
    v_exp_f32 v37, v37
    v_smfmac_f32_32x32x32_bf16 v[84:99], v[32:35], v[60:67], v5
    ds_read_b128 v[28:31], v4 offset:2048
    v_exp_f32 v38, v38
    v_exp_f32 v39, v39
    v_exp_f32 v40, v40
    v_exp_f32 v41, v41
    v_mfma_f32_32x32x16_bf16 v[52:67], v[16:19], v[12:15], 0
    ds_read_b128 v[16:19], v2 offset:34816
    v_exp_f32 v42, v42
    v_exp_f32 v43, v43
    v_exp_f32 v44, v44
    v_exp_f32 v45, v45
    v_exp_f32 v46, v46
    v_smfmac_f32_32x32x32_bf16 v[68:83], v[20:23], v[36:43], v5
    ds_read_b128 v[32:35], v4 offset:2560
    v_exp_f32 v47, v47
    v_exp_f32 v48, v48
    v_exp_f32 v49, v49
    v_exp_f32 v50, v50
    v_exp_f32 v51, v51
    v_exp_f32 v52, v52
    v_exp_f32 v53, v53
    v_smfmac_f32_32x32x32_bf16 v[68:83], v[24:27], v[44:51], v5
    s_waitcnt lgkmcnt(1)
    v_exp_f32 v54, v54
    v_exp_f32 v55, v55
    v_exp_f32 v56, v56
    v_exp_f32 v57, v57
    v_mfma_f32_32x32x16_bf16 v[36:51], v[16:19], v[8:11], 0
    s_cmp_lg_u32 s40, 7
    s_cbranch_scc1 L_at_nocnt
    s_lshl_b32 s45, s41, 4
    s_add_u32 s45, s45, s42
    s_lshl_b32 s45, s45, 3
    s_mov_b64 exec, 1
    v_mov_b32 v6, s45
    v_mov_b32 v7, 1
    buffer_atomic_add v7, v6, s[32:35], 0 offen offset:4 sc1
    s_mov_b64 exec, -1
L_at_nocnt:
    v_exp_f32 v58, v58
    v_exp_f32 v59, v59
    v_exp_f32 v60, v60
    v_exp_f32 v61, v61
    v_exp_f32 v62, v62
    v_smfmac_f32_32x32x32_bf16 v[84:99], v[20:23], v[52:59], v5
    s_waitcnt lgkmcnt(0)
    v_exp_f32 v63, v63
    v_exp_f32 v64, v64
    v_exp_f32 v65, v65
    v_exp_f32 v66, v66
    v_exp_f32 v67, v67
    v_exp_f32 v36, v36
    v_exp_f32 v37, v37
    v_smfmac_f32_32x32x32_bf16 v[84:99], v[24:27], v[60:67], v5
    ds_read_b128 v[20:23], v4 offset:4096
    v_exp_f32 v38, v38
    v_exp_f32 v39, v39
    v_exp_f32 v40, v40
    v_exp_f32 v41, v41
    v_mfma_f32_32x32x16_bf16 v[52:67], v[16:19], v[12:15], 0
    ds_read_b128 v[16:19], v2 offset:36864
    v_exp_f32 v42, v42
    v_exp_f32 v43, v43
    v_exp_f32 v44, v44
    v_exp_f32 v45, v45
    v_exp_f32 v46, v46
    v_smfmac_f32_32x32x32_bf16 v[68:83], v[28:31], v[36:43], v5
    ds_read_b128 v[24:27], v4 offset:4608
    v_exp_f32 v47, v47
    v_exp_f32 v48, v48
    v_exp_f32 v49, v49
    v_exp_f32 v50, v50
    v_exp_f32 v51, v51
    v_exp_f32 v52, v52
    v_exp_f32 v53, v53
    v_smfmac_f32_32x32x32_bf16 v[68:83], v[32:35], v[44:51], v5
    s_waitcnt lgkmcnt(1)
    v_exp_f32 v54, v54
    v_exp_f32 v55, v55
    v_exp_f32 v56, v56
    v_exp_f32 v57, v57
    v_mfma_f32_32x32x16_bf16 v[36:51], v[16:19], v[8:11], 0
    s_lshr_b32 s53, s40, 2
    s_lshr_b32 s45, s42, 3
    s_lshl_b32 s45, s45, 2
    s_and_b32 s46, s40, 3
    s_add_u32 s49, s45, s46
    v_exp_f32 v58, v58
    v_exp_f32 v59, v59
    v_exp_f32 v60, v60
    v_exp_f32 v61, v61
    v_exp_f32 v62, v62
    v_smfmac_f32_32x32x32_bf16 v[84:99], v[28:31], v[52:59], v5
    s_waitcnt lgkmcnt(0)
    v_exp_f32 v63, v63
    v_exp_f32 v64, v64
    v_exp_f32 v65, v65
    v_exp_f32 v66, v66
    v_exp_f32 v67, v67
    v_exp_f32 v36, v36
    v_exp_f32 v37, v37
    v_smfmac_f32_32x32x32_bf16 v[84:99], v[32:35], v[60:67], v5
    ds_read_b128 v[28:31], v4 offset:6144
    v_exp_f32 v38, v38
    v_exp_f32 v39, v39
    v_exp_f32 v40, v40
    v_exp_f32 v41, v41
    v_mfma_f32_32x32x16_bf16 v[52:67], v[16:19], v[12:15], 0
    ds_read_b128 v[16:19], v2 offset:38912
    v_exp_f32 v42, v42
    v_exp_f32 v43, v43
    v_exp_f32 v44, v44
    v_exp_f32 v45, v45
    v_exp_f32 v46, v46
    v_smfmac_f32_32x32x32_bf16 v[68:83], v[20:23], v[36:43], v5
    ds_read_b128 v[32:35], v4 offset:6656
    s_setprio 2
    v_exp_f32 v47, v47
    v_exp_f32 v48, v48
    v_exp_f32 v49, v49
    v_exp_f32 v50, v50
    v_exp_f32 v51, v51
    v_exp_f32 v52, v52
    v_exp_f32 v53, v53
    v_smfmac_f32_32x32x32_bf16 v[68:83], v[24:27], v[44:51], v5
    s_waitcnt lgkmcnt(1)
    v_exp_f32 v54, v54
    v_exp_f32 v55, v55
    v_exp_f32 v56, v56
    v_exp_f32 v57, v57
    v_mfma_f32_32x32x16_bf16 v[36:51], v[16:19], v[8:11], 0
    s_lshl_b32 s45, s43, 3
    s_add_u32 s49, s49, s45
    s_lshl_b32 s50, s49, 15
    s_lshl_b32 s45, s53, 14
    s_add_u32 s50, s50, s45
    v_exp_f32 v58, v58
    v_exp_f32 v59, v59
    v_exp_f32 v60, v60
    v_exp_f32 v61, v61
    v_exp_f32 v62, v62
    v_smfmac_f32_32x32x32_bf16 v[84:99], v[20:23], v[52:59], v5
    s_waitcnt lgkmcnt(0)
    v_exp_f32 v63, v63
    v_exp_f32 v64, v64
    v_exp_f32 v65, v65
    v_exp_f32 v66, v66
    v_exp_f32 v67, v67
    v_exp_f32 v36, v36
    v_exp_f32 v37, v37
    v_smfmac_f32_32x32x32_bf16 v[84:99], v[24:27], v[60:67], v5
    ds_read_b128 v[20:23], v4 offset:8192
    v_exp_f32 v38, v38
    v_exp_f32 v39, v39
    v_exp_f32 v40, v40
    v_exp_f32 v41, v41
    v_mfma_f32_32x32x16_bf16 v[52:67], v[16:19], v[12:15], 0
    ds_read_b128 v[16:19], v2 offset:40960
    v_exp_f32 v42, v42
    v_exp_f32 v43, v43
    v_exp_f32 v44, v44
    v_exp_f32 v45, v45
    v_exp_f32 v46, v46
    v_smfmac_f32_32x32x32_bf16 v[68:83], v[28:31], v[36:43], v5
    ds_read_b128 v[24:27], v4 offset:8704
    v_exp_f32 v47, v47
    v_exp_f32 v48, v48
    v_exp_f32 v49, v49
    v_exp_f32 v50, v50
    v_exp_f32 v51, v51
    v_exp_f32 v52, v52
    v_exp_f32 v53, v53
    v_smfmac_f32_32x32x32_bf16 v[68:83], v[32:35], v[44:51], v5
    s_waitcnt lgkmcnt(1)
    v_exp_f32 v54, v54
    v_exp_f32 v55, v55
    v_exp_f32 v56, v56
    v_exp_f32 v57, v57
    v_mfma_f32_32x32x16_bf16 v[36:51], v[16:19], v[8:11], 0
    s_mov_b32 s49, s50
    s_add_u32 s51, s50, 4096
    s_add_u32 s52, s50, 8192
    s_add_u32 s44, s50, 12288
    s_lshl_b32 s45, s41, 7
    v_exp_f32 v58, v58
    v_exp_f32 v59, v59
    v_exp_f32 v60, v60
    v_exp_f32 v61, v61
    v_exp_f32 v62, v62
    v_smfmac_f32_32x32x32_bf16 v[84:99], v[28:31], v[52:59], v5
    s_waitcnt lgkmcnt(0)
    v_exp_f32 v63, v63
    v_exp_f32 v64, v64
    v_exp_f32 v65, v65
    v_exp_f32 v66, v66
    v_exp_f32 v67, v67
    v_exp_f32 v36, v36
    v_exp_f32 v37, v37
    v_smfmac_f32_32x32x32_bf16 v[84:99], v[32:35], v[60:67], v5
    ds_read_b128 v[28:31], v4 offset:10240
    v_exp_f32 v38, v38
    v_exp_f32 v39, v39
    v_exp_f32 v40, v40
    v_exp_f32 v41, v41
    v_mfma_f32_32x32x16_bf16 v[52:67], v[16:19], v[12:15], 0
    ds_read_b128 v[16:19], v2 offset:43008
    v_exp_f32 v42, v42
    v_exp_f32 v43, v43
    v_exp_f32 v44, v44
    v_exp_f32 v45, v45
    v_exp_f32 v46, v46
    v_smfmac_f32_32x32x32_bf16 v[68:83], v[20:23], v[36:43], v5
    ds_read_b128 v[32:35], v4 offset:10752
    v_exp_f32 v47, v47
    v_exp_f32 v48, v48
    v_exp_f32 v49, v49
    v_exp_f32 v50, v50
    v_exp_f32 v51, v51
    v_exp_f32 v52, v52
    v_exp_f32 v53, v53
    v_smfmac_f32_32x32x32_bf16 v[68:83], v[24:27], v[44:51], v5
    s_waitcnt lgkmcnt(1)
    v_exp_f32 v54, v54
    v_exp_f32 v55, v55
    v_exp_f32 v56, v56
    v_exp_f32 v57, v57
    v_mfma_f32_32x32x16_bf16 v[36:51], v[16:19], v[8:11], 0
    v_and_b32 v6, 15, v0
    v_lshl_add_u32 v248, v6, 3, s45
    v_lshlrev_b32 v249, 10, v6
    v_exp_f32 v58, v58
    v_exp_f32 v59, v59
    v_exp_f32 v60, v60
    v_exp_f32 v61, v61
    v_exp_f32 v62, v62
    v_smfmac_f32_32x32x32_bf16 v[84:99], v[20:23], v[52:59], v5
    s_waitcnt lgkmcnt(0)
    s_setprio 1
    v_exp_f32 v63, v63
    v_exp_f32 v64, v64
    v_exp_f32 v65, v65
    v_exp_f32 v66, v66
    v_exp_f32 v67, v67
    v_exp_f32 v36, v36
    v_exp_f32 v37, v37
    v_smfmac_f32_32x32x32_bf16 v[84:99], v[24:27], v[60:67], v5
    ds_read_b128 v[20:23], v4 offset:12288
    v_exp_f32 v38, v38
    v_exp_f32 v39, v39
    v_exp_f32 v40, v40
    v_exp_f32 v41, v41
    v_mfma_f32_32x32x16_bf16 v[52:67], v[16:19], v[12:15], 0
    ds_read_b128 v[16:19], v2 offset:45056
    v_exp_f32 v42, v42
    v_exp_f32 v43, v43
    v_exp_f32 v44, v44
    v_exp_f32 v45, v45
    v_exp_f32 v46, v46
    v_smfmac_f32_32x32x32_bf16 v[68:83], v[28:31], v[36:43], v5
    ds_read_b128 v[24:27], v4 offset:12800
    v_exp_f32 v47, v47
    v_exp_f32 v48, v48
    v_exp_f32 v49, v49
    v_exp_f32 v50, v50
    v_exp_f32 v51, v51
    v_exp_f32 v52, v52
    v_exp_f32 v53, v53
    v_smfmac_f32_32x32x32_bf16 v[68:83], v[32:35], v[44:51], v5
    s_waitcnt lgkmcnt(1)
    v_exp_f32 v54, v54
    v_exp_f32 v55, v55
    v_exp_f32 v56, v56
    v_exp_f32 v57, v57
    v_mfma_f32_32x32x16_bf16 v[36:51], v[16:19], v[8:11], 0
    v_mov_b32 v236, 0
    v_exp_f32 v58, v58
    v_exp_f32 v59, v59
    v_exp_f32 v60, v60
    v_exp_f32 v61, v61
    v_exp_f32 v62, v62
    v_smfmac_f32_32x32x32_bf16 v[84:99], v[28:31], v[52:59], v5
    s_waitcnt lgkmcnt(0)
    v_exp_f32 v63, v63
    v_exp_f32 v64, v64
    v_exp_f32 v65, v65
    v_exp_f32 v66, v66
    v_exp_f32 v67, v67
    v_exp_f32 v36, v36
    v_exp_f32 v37, v37
    v_smfmac_f32_32x32x32_bf16 v[84:99], v[32:35], v[60:67], v5
    ds_read_b128 v[28:31], v4 offset:14336
    v_exp_f32 v38, v38
    v_exp_f32 v39, v39
    v_exp_f32 v40, v40
    v_exp_f32 v41, v41
    v_mfma_f32_32x32x16_bf16 v[52:67], v[16:19], v[12:15], 0
    ds_read_b128 v[16:19], v2 offset:47104
    v_exp_f32 v42, v42
    v_exp_f32 v43, v43
    v_exp_f32 v44, v44
    v_exp_f32 v45, v45
    v_exp_f32 v46, v46
    v_smfmac_f32_32x32x32_bf16 v[68:83], v[20:23], v[36:43], v5
    ds_read_b128 v[32:35], v4 offset:14848
    v_exp_f32 v47, v47
    v_exp_f32 v48, v48
    v_exp_f32 v49, v49
    v_exp_f32 v50, v50
    v_exp_f32 v51, v51
    v_exp_f32 v52, v52
    v_exp_f32 v53, v53
    v_smfmac_f32_32x32x32_bf16 v[68:83], v[24:27], v[44:51], v5
    s_waitcnt lgkmcnt(1)
    v_exp_f32 v54, v54
    v_exp_f32 v55, v55
    v_exp_f32 v56, v56
    v_exp_f32 v57, v57
    v_mfma_f32_32x32x16_bf16 v[36:51], v[16:19], v[8:11], 0
    buffer_load_dword v236, v248, s[32:35], 0 offen offset:4 sc1
    v_exp_f32 v58, v58
    v_exp_f32 v59, v59
    v_exp_f32 v60, v60
    v_exp_f32 v61, v61
    v_exp_f32 v62, v62
    v_smfmac_f32_32x32x32_bf16 v[84:99], v[20:23], v[52:59], v5
    s_waitcnt lgkmcnt(0)
    v_exp_f32 v63, v63
    v_exp_f32 v64, v64
    v_exp_f32 v65, v65
    v_exp_f32 v66, v66
    v_exp_f32 v67, v67
    v_exp_f32 v36, v36
    v_exp_f32 v37, v37
    v_smfmac_f32_32x32x32_bf16 v[84:99], v[24:27], v[60:67], v5
    v_exp_f32 v38, v38
    v_exp_f32 v39, v39
    v_exp_f32 v40, v40
    v_exp_f32 v41, v41
    v_mfma_f32_32x32x16_bf16 v[52:67], v[16:19], v[12:15], 0
    s_nop 0
    v_exp_f32 v42, v42
    v_exp_f32 v43, v43
    v_exp_f32 v44, v44
    v_exp_f32 v45, v45
    v_exp_f32 v46, v46
    v_smfmac_f32_32x32x32_bf16 v[68:83], v[28:31], v[36:43], v5
    v_exp_f32 v47, v47
    v_exp_f32 v48, v48
    v_exp_f32 v49, v49
    v_exp_f32 v50, v50
    v_exp_f32 v51, v51
    v_exp_f32 v52, v52
    v_exp_f32 v53, v53
    v_smfmac_f32_32x32x32_bf16 v[68:83], v[32:35], v[44:51], v5
    v_exp_f32 v54, v54
    v_exp_f32 v55, v55
    v_exp_f32 v56, v56
    v_exp_f32 v57, v57
    v_exp_f32 v58, v58
    v_exp_f32 v59, v59
    v_exp_f32 v60, v60
    v_exp_f32 v61, v61
    v_exp_f32 v62, v62
    v_smfmac_f32_32x32x32_bf16 v[84:99], v[28:31], v[52:59], v5
    v_exp_f32 v63, v63
    v_exp_f32 v64, v64
    v_exp_f32 v65, v65
    v_exp_f32 v66, v66
    v_exp_f32 v67, v67
L_at_done:
    s_nop 1
    v_smfmac_f32_32x32x32_bf16 v[84:99], v[32:35], v[60:67], v5
    s_mov_b32 s45, 0x2b800000
    s_mov_b32 s46, 0x53800000
    s_mov_b32 s47, 0x7f800000
    v_maximum3_f32 v6, abs(v68), abs(v69), abs(v70)
    v_maximum3_f32 v7, abs(v71), abs(v72), abs(v73)
    v_maximum3_f32 v6, v6, abs(v74), abs(v75)
    v_maximum3_f32 v6, v6, v7, v7
    v_cmp_nle_f32 s[56:57], s45, v76
    v_cmp_nge_f32 s[58:59], s46, v76
    v_cmp_ngt_f32 vcc, s47, v6
    v_rcp_f32 v36, v76
    s_or_b64 s[56:57], s[56:57], s[58:59]
    s_or_b64 s[56:57], s[56:57], vcc
    s_cbranch_scc1 L_fallback
    v_maximum3_f32 v6, abs(v84), abs(v85), abs(v86)
    v_maximum3_f32 v7, abs(v87), abs(v88), abs(v89)
    v_maximum3_f32 v6, v6, abs(v90), abs(v91)
    v_maximum3_f32 v6, v6, v7, v7
    v_cmp_nle_f32 s[56:57], s45, v92
    v_cmp_nge_f32 s[58:59], s46, v92
    v_cmp_ngt_f32 vcc, s47, v6
    v_rcp_f32 v38, v92
    s_or_b64 s[56:57], s[56:57], s[58:59]
    s_or_b64 s[56:57], s[56:57], vcc
    s_cbranch_scc1 L_fallback
L_at_store:
    v_pk_mul_f32 v[68:69], v[68:69], v[36:37] op_sel_hi:[1,0]
    v_pk_mul_f32 v[70:71], v[70:71], v[36:37] op_sel_hi:[1,0]
    v_pk_mul_f32 v[72:73], v[72:73], v[36:37] op_sel_hi:[1,0]
    v_pk_mul_f32 v[74:75], v[74:75], v[36:37] op_sel_hi:[1,0]
    v_cvt_pk_bf16_f32 v68, v68, v69
    v_cvt_pk_bf16_f32 v69, v70, v71
    v_cvt_pk_bf16_f32 v70, v72, v73
    v_cvt_pk_bf16_f32 v71, v74, v75
    buffer_store_dwordx4 v[68:71], v1, s[24:27], s62 offen sc1
    v_pk_mul_f32 v[84:85], v[84:85], v[38:39] op_sel_hi:[1,0]
    v_pk_mul_f32 v[86:87], v[86:87], v[38:39] op_sel_hi:[1,0]
    v_pk_mul_f32 v[88:89], v[88:89], v[38:39] op_sel_hi:[1,0]
    v_pk_mul_f32 v[90:91], v[90:91], v[38:39] op_sel_hi:[1,0]
    v_cvt_pk_bf16_f32 v84, v84, v85
    v_cvt_pk_bf16_f32 v85, v86, v87
    v_cvt_pk_bf16_f32 v86, v88, v89
    v_cvt_pk_bf16_f32 v87, v90, v91
    buffer_store_dwordx4 v[84:87], v1, s[24:27], s63 offen sc1
    s_setprio 0
    s_waitcnt vmcnt(2)
    v_cmp_gt_u32 vcc, 8, v236
    s_mov_b32 s48, 0
    s_lshl_b32 s45, s53, 15
    s_add_u32 s45, s45, 65536
    v_lshrrev_b32 v6, 5, v0
    v_bfe_u32 v7, v0, 2, 2
    v_lshl_add_u32 v6, v6, 2, v7
    v_lshl_add_u32 v6, v6, 7, s45
    v_bfe_u32 v7, v0, 3, 2
    v_and_b32 v2, 1, v7
    v_lshl_add_u32 v6, v2, 6, v6
    v_lshrrev_b32 v7, 1, v7
    v_lshl_add_u32 v6, v7, 5, v6
    v_and_b32 v7, 3, v0
    v_lshl_add_u32 v6, v7, 3, v6
    s_lshl_b32 s45, s53, 6
    v_xor_b32 v244, s45, v6
    v_xor_b32 v245, 64, v244
    ds_read_b64_tr_b16 v[100:101], v244 offset:0
    ds_read_b64_tr_b16 v[102:103], v244 offset:1024
    ds_read_b64_tr_b16 v[104:105], v245 offset:0
    ds_read_b64_tr_b16 v[106:107], v245 offset:1024
    ds_read_b64_tr_b16 v[108:109], v244 offset:2048
    ds_read_b64_tr_b16 v[110:111], v244 offset:3072
    ds_read_b64_tr_b16 v[112:113], v245 offset:2048
    ds_read_b64_tr_b16 v[114:115], v245 offset:3072
    ds_read_b64_tr_b16 v[116:117], v244 offset:4096
    ds_read_b64_tr_b16 v[118:119], v244 offset:5120
    ds_read_b64_tr_b16 v[120:121], v245 offset:4096
    ds_read_b64_tr_b16 v[122:123], v245 offset:5120
    s_waitcnt lgkmcnt(2)
    ds_read_b64_tr_b16 v[124:125], v244 offset:6144
    ds_read_b64_tr_b16 v[126:127], v244 offset:7168
    ds_read_b64_tr_b16 v[128:129], v245 offset:6144
    ds_read_b64_tr_b16 v[130:131], v245 offset:7168
    ds_read_b64_tr_b16 v[132:133], v244 offset:8192
    ds_read_b64_tr_b16 v[134:135], v244 offset:9216
    ds_read_b64_tr_b16 v[136:137], v245 offset:8192
    ds_read_b64_tr_b16 v[138:139], v245 offset:9216
    ds_read_b64_tr_b16 v[140:141], v244 offset:10240
    ds_read_b64_tr_b16 v[142:143], v244 offset:11264
    ds_read_b64_tr_b16 v[144:145], v245 offset:10240
    ds_read_b64_tr_b16 v[146:147], v245 offset:11264
    s_waitcnt lgkmcnt(2)
    ds_read_b64_tr_b16 v[148:149], v244 offset:12288
    ds_read_b64_tr_b16 v[150:151], v244 offset:13312
    ds_read_b64_tr_b16 v[152:153], v245 offset:12288
    ds_read_b64_tr_b16 v[154:155], v245 offset:13312
    ds_read_b64_tr_b16 v[156:157], v244 offset:14336
    ds_read_b64_tr_b16 v[158:159], v244 offset:15360
    ds_read_b64_tr_b16 v[160:161], v245 offset:14336
    ds_read_b64_tr_b16 v[162:163], v245 offset:15360
    ds_read_b64_tr_b16 v[164:165], v244 offset:16384
    ds_read_b64_tr_b16 v[166:167], v244 offset:17408
    ds_read_b64_tr_b16 v[168:169], v245 offset:16384
    ds_read_b64_tr_b16 v[170:171], v245 offset:17408
    s_waitcnt lgkmcnt(2)
    ds_read_b64_tr_b16 v[172:173], v244 offset:18432
    ds_read_b64_tr_b16 v[174:175], v244 offset:19456
    ds_read_b64_tr_b16 v[176:177], v245 offset:18432
    ds_read_b64_tr_b16 v[178:179], v245 offset:19456
    ds_read_b64_tr_b16 v[180:181], v244 offset:20480
    ds_read_b64_tr_b16 v[182:183], v244 offset:21504
    ds_read_b64_tr_b16 v[184:185], v245 offset:20480
    ds_read_b64_tr_b16 v[186:187], v245 offset:21504
    ds_read_b64_tr_b16 v[188:189], v244 offset:22528
    ds_read_b64_tr_b16 v[190:191], v244 offset:23552
    ds_read_b64_tr_b16 v[192:193], v245 offset:22528
    ds_read_b64_tr_b16 v[194:195], v245 offset:23552
    s_waitcnt lgkmcnt(2)
    ds_read_b64_tr_b16 v[196:197], v244 offset:24576
    ds_read_b64_tr_b16 v[198:199], v244 offset:25600
    ds_read_b64_tr_b16 v[200:201], v245 offset:24576
    ds_read_b64_tr_b16 v[202:203], v245 offset:25600
    ds_read_b64_tr_b16 v[204:205], v244 offset:26624
    ds_read_b64_tr_b16 v[206:207], v244 offset:27648
    ds_read_b64_tr_b16 v[208:209], v245 offset:26624
    ds_read_b64_tr_b16 v[210:211], v245 offset:27648
    ds_read_b64_tr_b16 v[212:213], v244 offset:28672
    ds_read_b64_tr_b16 v[214:215], v244 offset:29696
    ds_read_b64_tr_b16 v[216:217], v245 offset:28672
    ds_read_b64_tr_b16 v[218:219], v245 offset:29696
    s_waitcnt lgkmcnt(2)
    ds_read_b64_tr_b16 v[220:221], v244 offset:30720
    ds_read_b64_tr_b16 v[222:223], v244 offset:31744
    ds_read_b64_tr_b16 v[224:225], v245 offset:30720
    ds_read_b64_tr_b16 v[226:227], v245 offset:31744
    s_lshl_b32 s45, s40, 12
    v_add_u32 v246, s45, v1
    s_and_b32 s45, s40, 3
    s_lshl_b32 s45, s45, 12
    s_add_u32 s45, s45, 32768
    v_and_b32 v6, 31, v0
    v_lshl_add_u32 v6, v6, 7, s45
    v_lshrrev_b32 v7, 5, v0
    v_lshl_add_u32 v7, s53, 2, v7
    v_and_b32 v91, 7, v0
    v_xor_b32 v7, v7, v91
    v_lshl_add_u32 v88, v7, 4, v6
    v_xor_b32 v89, 32, v88
    v_lshrrev_b32 v6, 3, v0
    v_xor_b32 v7, v6, v91
    v_lshl_add_u32 v6, v6, 7, s45
    v_lshl_add_u32 v6, v7, 4, v6
    v_lshl_add_u32 v90, s53, 11, v6
    s_cbranch_vccz L_spin_o
L_spin_c:
    buffer_load_dword v5, v248, s[32:35], 0 offen offset:4 sc1
    s_add_u32 s48, s48, 1
    s_cmp_ge_u32 s48, 1048576
    s_cbranch_scc1 L_spin_o
    s_waitcnt vmcnt(0)
    v_cmp_gt_u32 vcc, 8, v5
    s_cbranch_vccnz L_spin_c
L_spin_o:
    buffer_load_dword v3, v249, s[24:27], s50 offen offset:1020 sc1
    s_add_u32 s48, s48, 1
    s_cmp_ge_u32 s48, 1048576
    s_cbranch_scc1 L_spun_o
    s_waitcnt vmcnt(0)
    v_cmp_eq_u32 vcc, -1, v3
    s_cbranch_vccnz L_spin_o
L_spun_o:
    buffer_load_dwordx4 v[8:11], v1, s[24:27], s49 offen offset:0 sc1
    buffer_load_dwordx4 v[12:15], v1, s[24:27], s49 offen offset:1024 sc1
    buffer_load_dwordx4 v[16:19], v1, s[24:27], s49 offen offset:2048 sc1
    buffer_load_dwordx4 v[20:23], v1, s[24:27], s49 offen offset:3072 sc1
    buffer_load_dwordx4 v[24:27], v1, s[24:27], s51 offen offset:0 sc1
    buffer_load_dwordx4 v[28:31], v1, s[24:27], s51 offen offset:1024 sc1
L_op_mm:
    v_mov_b32 v3, 0
    s_waitcnt lgkmcnt(0)
    s_waitcnt vmcnt(5)
    buffer_load_dwordx4 v[32:35], v1, s[24:27], s51 offen offset:2048 sc1
    v_mfma_f32_32x32x16_bf16 v[72:87], v[104:107], v[8:11], 0
    v_max3_u32 v3, v3, v10, v11
    v_mfma_f32_32x32x16_bf16 v[228:243], v[100:103], v[8:11], 0
    v_max3_u32 v3, v3, v8, v9
    s_waitcnt vmcnt(5)
    buffer_load_dwordx4 v[36:39], v1, s[24:27], s51 offen offset:3072 sc1
    v_mfma_f32_32x32x16_bf16 v[72:87], v[112:115], v[12:15], v[72:87]
    v_max3_u32 v3, v3, v14, v15
    v_mfma_f32_32x32x16_bf16 v[228:243], v[108:111], v[12:15], v[228:243]
    v_max3_u32 v3, v3, v12, v13
    s_waitcnt vmcnt(5)
    buffer_load_dwordx4 v[40:43], v1, s[24:27], s52 offen offset:0 sc1
    v_mfma_f32_32x32x16_bf16 v[72:87], v[120:123], v[16:19], v[72:87]
    v_max3_u32 v3, v3, v18, v19
    v_mfma_f32_32x32x16_bf16 v[228:243], v[116:119], v[16:19], v[228:243]
    v_max3_u32 v3, v3, v16, v17
    s_waitcnt vmcnt(5)
    buffer_load_dwordx4 v[44:47], v1, s[24:27], s52 offen offset:1024 sc1
    v_mfma_f32_32x32x16_bf16 v[72:87], v[128:131], v[20:23], v[72:87]
    v_max3_u32 v3, v3, v22, v23
    v_mfma_f32_32x32x16_bf16 v[228:243], v[124:127], v[20:23], v[228:243]
    v_max3_u32 v3, v3, v20, v21
    s_waitcnt vmcnt(5)
    buffer_load_dwordx4 v[48:51], v1, s[24:27], s52 offen offset:2048 sc1
    v_mfma_f32_32x32x16_bf16 v[72:87], v[136:139], v[24:27], v[72:87]
    v_max3_u32 v3, v3, v26, v27
    v_mfma_f32_32x32x16_bf16 v[228:243], v[132:135], v[24:27], v[228:243]
    v_max3_u32 v3, v3, v24, v25
    s_waitcnt vmcnt(5)
    buffer_load_dwordx4 v[52:55], v1, s[24:27], s52 offen offset:3072 sc1
    v_mfma_f32_32x32x16_bf16 v[72:87], v[144:147], v[28:31], v[72:87]
    v_max3_u32 v3, v3, v30, v31
    v_mfma_f32_32x32x16_bf16 v[228:243], v[140:143], v[28:31], v[228:243]
    v_max3_u32 v3, v3, v28, v29
    s_waitcnt vmcnt(5)
    buffer_load_dwordx4 v[56:59], v1, s[24:27], s44 offen offset:0 sc1
    v_mfma_f32_32x32x16_bf16 v[72:87], v[152:155], v[32:35], v[72:87]
    v_max3_u32 v3, v3, v34, v35
    v_mfma_f32_32x32x16_bf16 v[228:243], v[148:151], v[32:35], v[228:243]
    v_max3_u32 v3, v3, v32, v33
    s_waitcnt vmcnt(5)
    buffer_load_dwordx4 v[60:63], v1, s[24:27], s44 offen offset:1024 sc1
    v_mfma_f32_32x32x16_bf16 v[72:87], v[160:163], v[36:39], v[72:87]
    v_max3_u32 v3, v3, v38, v39
    v_mfma_f32_32x32x16_bf16 v[228:243], v[156:159], v[36:39], v[228:243]
    v_max3_u32 v3, v3, v36, v37
    s_waitcnt vmcnt(5)
    buffer_load_dwordx4 v[64:67], v1, s[24:27], s44 offen offset:2048 sc1
    v_mfma_f32_32x32x16_bf16 v[72:87], v[168:171], v[40:43], v[72:87]
    v_max3_u32 v3, v3, v42, v43
    v_mfma_f32_32x32x16_bf16 v[228:243], v[164:167], v[40:43], v[228:243]
    v_max3_u32 v3, v3, v40, v41
    s_waitcnt vmcnt(5)
    buffer_load_dwordx4 v[68:71], v1, s[24:27], s44 offen offset:3072 sc1
    v_mfma_f32_32x32x16_bf16 v[72:87], v[176:179], v[44:47], v[72:87]
    v_max3_u32 v3, v3, v46, v47
    v_mfma_f32_32x32x16_bf16 v[228:243], v[172:175], v[44:47], v[228:243]
    v_max3_u32 v3, v3, v44, v45
    s_waitcnt vmcnt(5)
    v_mfma_f32_32x32x16_bf16 v[72:87], v[184:187], v[48:51], v[72:87]
    v_max3_u32 v3, v3, v50, v51
    v_mfma_f32_32x32x16_bf16 v[228:243], v[180:183], v[48:51], v[228:243]
    v_max3_u32 v3, v3, v48, v49
    s_waitcnt vmcnt(4)
    v_mfma_f32_32x32x16_bf16 v[72:87], v[192:195], v[52:55], v[72:87]
    v_max3_u32 v3, v3, v54, v55
    v_mfma_f32_32x32x16_bf16 v[228:243], v[188:191], v[52:55], v[228:243]
    v_max3_u32 v3, v3, v52, v53
    s_waitcnt vmcnt(3)
    v_mfma_f32_32x32x16_bf16 v[72:87], v[200:203], v[56:59], v[72:87]
    v_max3_u32 v3, v3, v58, v59
    v_mfma_f32_32x32x16_bf16 v[228:243], v[196:199], v[56:59], v[228:243]
    v_max3_u32 v3, v3, v56, v57
    s_waitcnt vmcnt(2)
    v_mfma_f32_32x32x16_bf16 v[72:87], v[208:211], v[60:63], v[72:87]
    v_max3_u32 v3, v3, v62, v63
    v_mfma_f32_32x32x16_bf16 v[228:243], v[204:207], v[60:63], v[228:243]
    v_max3_u32 v3, v3, v60, v61
    s_waitcnt vmcnt(1)
    v_mfma_f32_32x32x16_bf16 v[72:87], v[216:219], v[64:67], v[72:87]
    v_max3_u32 v3, v3, v66, v67
    v_mfma_f32_32x32x16_bf16 v[228:243], v[212:215], v[64:67], v[228:243]
    v_max3_u32 v3, v3, v64, v65
    s_waitcnt vmcnt(0)
    v_mfma_f32_32x32x16_bf16 v[72:87], v[224:227], v[68:71], v[72:87]
    v_max3_u32 v3, v3, v70, v71
    v_mfma_f32_32x32x16_bf16 v[228:243], v[220:223], v[68:71], v[228:243]
    v_max3_u32 v3, v3, v68, v69
    v_cmp_eq_u32 vcc, -1, v3
    s_cmp_ge_u32 s48, 1048576
    s_cbranch_scc1 L_op_go
    s_cbranch_vccnz L_spin_o
L_op_go:
    s_nop 5
    ds_write_b128 v246, v[72:75] offset:0
    ds_write_b128 v246, v[76:79] offset:1024
    ds_write_b128 v246, v[80:83] offset:2048
    ds_write_b128 v246, v[84:87] offset:3072
    s_waitcnt lgkmcnt(0)
    v_xor_b32 v246, 16384, v246
    s_barrier
L_nb_b9:
    ds_read_b128 v[8:11], v246 offset:0
    ds_read_b128 v[12:15], v246 offset:1024
    ds_read_b128 v[16:19], v246 offset:2048
    ds_read_b128 v[20:23], v246 offset:3072
    s_waitcnt lgkmcnt(3)
    v_add_f32 v228, v228, v8
    v_add_f32 v229, v229, v9
    v_add_f32 v230, v230, v10
    v_add_f32 v231, v231, v11
    v_cvt_pk_bf16_f32 v24, v228, v229
    v_cvt_pk_bf16_f32 v25, v230, v231
    s_waitcnt lgkmcnt(2)
    v_add_f32 v232, v232, v12
    v_add_f32 v233, v233, v13
    v_add_f32 v234, v234, v14
    v_add_f32 v235, v235, v15
    v_cvt_pk_bf16_f32 v26, v232, v233
    v_cvt_pk_bf16_f32 v27, v234, v235
    s_nop 1
    v_permlane32_swap_b32 v24, v26
    v_permlane32_swap_b32 v25, v27
    ds_write_b128 v88, v[24:27]
    s_waitcnt lgkmcnt(1)
    v_add_f32 v236, v236, v16
    v_add_f32 v237, v237, v17
    v_add_f32 v238, v238, v18
    v_add_f32 v239, v239, v19
    v_cvt_pk_bf16_f32 v28, v236, v237
    v_cvt_pk_bf16_f32 v29, v238, v239
    s_waitcnt lgkmcnt(0)
    v_add_f32 v240, v240, v20
    v_add_f32 v241, v241, v21
    v_add_f32 v242, v242, v22
    v_add_f32 v243, v243, v23
    v_cvt_pk_bf16_f32 v30, v240, v241
    v_cvt_pk_bf16_f32 v31, v242, v243
    s_nop 1
    v_permlane32_swap_b32 v28, v30
    v_permlane32_swap_b32 v29, v31
    ds_write_b128 v89, v[28:31]
    s_add_u32 s45, s1, 16384
    s_waitcnt lgkmcnt(0)
    s_barrier
L_nb_b10:
    ds_read_b128 v[24:27], v90
    ds_read_b128 v[28:31], v90 offset:1024
    s_waitcnt lgkmcnt(1)
    buffer_store_dwordx4 v[24:27], v251, s[36:39], s1 offen
    s_waitcnt lgkmcnt(0)
    buffer_store_dwordx4 v[28:31], v251, s[36:39], s45 offen
L_end:
    s_endpgm
L_code_end:
L_ol_kv0:
    s_mov_b32 s48, 0
L_spin_kv0:
    buffer_load_dword v241, v242, s[28:31], 0 offen sc1
    s_add_u32 s48, s48, 1
    s_waitcnt vmcnt(0)
    v_cmp_ne_u32 vcc, 1, v241
    s_cmp_ge_u32 s48, 1048576
    s_cbranch_scc1 L_olr_kv0
    s_and_b32 vcc_lo, vcc_lo, s61
    s_cbranch_scc1 L_spin_kv0
    s_branch L_olr_kv0
L_ol_kv1:
    s_mov_b32 s48, 0
L_spin_kv1:
    buffer_load_dword v241, v242, s[28:31], 0 offen sc1
    s_add_u32 s48, s48, 1
    s_waitcnt vmcnt(0)
    v_cmp_ne_u32 vcc, 1, v241
    s_cmp_ge_u32 s48, 1048576
    s_cbranch_scc1 L_olr_kv1
    s_and_b32 vcc_lo, vcc_lo, s61
    s_cbranch_scc1 L_spin_kv1
    s_branch L_olr_kv1
L_ol_kv2:
    s_mov_b32 s48, 0
L_spin_kv2:
    buffer_load_dword v241, v242, s[28:31], 0 offen sc1
    s_add_u32 s48, s48, 1
    s_waitcnt vmcnt(0)
    v_cmp_ne_u32 vcc, 1, v241
    s_cmp_ge_u32 s48, 1048576
    s_cbranch_scc1 L_olr_kv2
    s_and_b32 vcc_lo, vcc_lo, s61
    s_cbranch_scc1 L_spin_kv2
    s_branch L_olr_kv2
L_fallback:
    s_lshr_b32 s45, s40, 2
    s_lshl_b32 s45, s45, 17
    v_mov_b32 v132, 0xff800000
    v_mov_b32 v133, 0xff800000
    s_mov_b32 s46, s45
    s_add_u32 s47, s45, 131072
L_fb_max:
    buffer_load_dwordx4 v[16:19], v1, s[20:23], s46 offen sc1
    s_add_u32 s46, s46, 2048
    s_waitcnt vmcnt(0)
    v_mfma_f32_32x32x16_bf16 v[36:51], v[16:19], v[8:11], 0
    v_mfma_f32_32x32x16_bf16 v[52:67], v[16:19], v[12:15], 0
    s_nop 15
    v_max3_f32 v132, v132, v36, v37
    v_max3_f32 v132, v132, v38, v39
    v_max3_f32 v132, v132, v40, v41
    v_max3_f32 v132, v132, v42, v43
    v_max3_f32 v132, v132, v44, v45
    v_max3_f32 v132, v132, v46, v47
    v_max3_f32 v132, v132, v48, v49
    v_max3_f32 v132, v132, v50, v51
    v_max3_f32 v133, v133, v52, v53
    v_max3_f32 v133, v133, v54, v55
    v_max3_f32 v133, v133, v56, v57
    v_max3_f32 v133, v133, v58, v59
    v_max3_f32 v133, v133, v60, v61
    v_max3_f32 v133, v133, v62, v63
    v_max3_f32 v133, v133, v64, v65
    v_max3_f32 v133, v133, v66, v67
    s_cmp_lt_u32 s46, s47
    s_cbranch_scc1 L_fb_max
    v_mov_b32 v6, v132
    v_mov_b32 v7, v132
    s_nop 1
    v_permlane32_swap_b32 v6, v7
    s_nop 1
    v_max_f32 v6, v6, v7
    v_sub_f32 v100, 0, v6
    v_mov_b32 v68, 0
    v_sub_f32 v101, 0, v6
    v_mov_b32 v69, 0
    v_sub_f32 v102, 0, v6
    v_mov_b32 v70, 0
    v_sub_f32 v103, 0, v6
    v_mov_b32 v71, 0
    v_sub_f32 v104, 0, v6
    v_mov_b32 v72, 0
    v_sub_f32 v105, 0, v6
    v_mov_b32 v73, 0
    v_sub_f32 v106, 0, v6
    v_mov_b32 v74, 0
    v_sub_f32 v107, 0, v6
    v_mov_b32 v75, 0
    v_sub_f32 v108, 0, v6
    v_mov_b32 v76, 0
    v_sub_f32 v109, 0, v6
    v_mov_b32 v77, 0
    v_sub_f32 v110, 0, v6
    v_mov_b32 v78, 0
    v_sub_f32 v111, 0, v6
    v_mov_b32 v79, 0
    v_sub_f32 v112, 0, v6
    v_mov_b32 v80, 0
    v_sub_f32 v113, 0, v6
    v_mov_b32 v81, 0
    v_sub_f32 v114, 0, v6
    v_mov_b32 v82, 0
    v_sub_f32 v115, 0, v6
    v_mov_b32 v83, 0
    v_mov_b32 v6, v133
    v_mov_b32 v7, v133
    s_nop 1
    v_permlane32_swap_b32 v6, v7
    s_nop 1
    v_max_f32 v6, v6, v7
    v_sub_f32 v116, 0, v6
    v_mov_b32 v84, 0
    v_sub_f32 v117, 0, v6
    v_mov_b32 v85, 0
    v_sub_f32 v118, 0, v6
    v_mov_b32 v86, 0
    v_sub_f32 v119, 0, v6
    v_mov_b32 v87, 0
    v_sub_f32 v120, 0, v6
    v_mov_b32 v88, 0
    v_sub_f32 v121, 0, v6
    v_mov_b32 v89, 0
    v_sub_f32 v122, 0, v6
    v_mov_b32 v90, 0
    v_sub_f32 v123, 0, v6
    v_mov_b32 v91, 0
    v_sub_f32 v124, 0, v6
    v_mov_b32 v92, 0
    v_sub_f32 v125, 0, v6
    v_mov_b32 v93, 0
    v_sub_f32 v126, 0, v6
    v_mov_b32 v94, 0
    v_sub_f32 v127, 0, v6
    v_mov_b32 v95, 0
    v_sub_f32 v128, 0, v6
    v_mov_b32 v96, 0
    v_sub_f32 v129, 0, v6
    v_mov_b32 v97, 0
    v_sub_f32 v130, 0, v6
    v_mov_b32 v98, 0
    v_sub_f32 v131, 0, v6
    v_mov_b32 v99, 0
    v_and_b32 v6, 15, v0
    v_lshlrev_b32 v6, 4, v6
    v_lshrrev_b32 v7, 5, v0
    v_lshl_add_u32 v134, v7, 8, v6
    v_mov_b32 v20, 0x3f803f80
    v_mov_b32 v21, 0x3f803f80
    v_mov_b32 v22, 0x3f803f80
    v_mov_b32 v23, 0x3f803f80
    v_mov_b32 v24, 0x3f803f80
    v_mov_b32 v25, 0x3f803f80
    v_mov_b32 v26, 0x3f803f80
    v_mov_b32 v27, 0x3f803f80
    s_mov_b32 s46, s45
    s_mov_b32 s56, 0xffff
    s_mov_b32 s57, 0xffff
L_fb_pv:
    buffer_load_dwordx4 v[16:19], v1, s[20:23], s46 offen sc1
    s_mov_b64 exec, s[56:57]
    buffer_load_dwordx4 v[20:23], v134, s[20:23], s46 offen offset:1024 sc1
    buffer_load_dwordx4 v[24:27], v134, s[20:23], s46 offen offset:1536 sc1
    s_mov_b64 exec, -1
    s_add_u32 s46, s46, 2048
    s_waitcnt vmcnt(0)
    v_mfma_f32_32x32x16_bf16 v[36:51], v[16:19], v[8:11], v[100:115]
    v_mfma_f32_32x32x16_bf16 v[52:67], v[16:19], v[12:15], v[116:131]
    s_nop 15
    v_exp_f32 v36, v36
    v_exp_f32 v37, v37
    v_exp_f32 v38, v38
    v_exp_f32 v39, v39
    v_exp_f32 v40, v40
    v_exp_f32 v41, v41
    v_exp_f32 v42, v42
    v_exp_f32 v43, v43
    v_exp_f32 v44, v44
    v_exp_f32 v45, v45
    v_exp_f32 v46, v46
    v_exp_f32 v47, v47
    v_exp_f32 v48, v48
    v_exp_f32 v49, v49
    v_exp_f32 v50, v50
    v_exp_f32 v51, v51
    v_exp_f32 v52, v52
    v_exp_f32 v53, v53
    v_exp_f32 v54, v54
    v_exp_f32 v55, v55
    v_exp_f32 v56, v56
    v_exp_f32 v57, v57
    v_exp_f32 v58, v58
    v_exp_f32 v59, v59
    v_exp_f32 v60, v60
    v_exp_f32 v61, v61
    v_exp_f32 v62, v62
    v_exp_f32 v63, v63
    v_exp_f32 v64, v64
    v_exp_f32 v65, v65
    v_exp_f32 v66, v66
    v_exp_f32 v67, v67
    s_nop 3
    v_smfmac_f32_32x32x32_bf16 v[68:83], v[20:23], v[36:43], v5
    v_smfmac_f32_32x32x32_bf16 v[68:83], v[24:27], v[44:51], v5
    v_smfmac_f32_32x32x32_bf16 v[84:99], v[20:23], v[52:59], v5
    v_smfmac_f32_32x32x32_bf16 v[84:99], v[24:27], v[60:67], v5
    s_nop 15
    s_cmp_lt_u32 s46, s47
    s_cbranch_scc1 L_fb_pv
    v_rcp_f32 v36, v76
    v_rcp_f32 v38, v92
    s_nop 1
    s_branch L_at_store
.section .rodata,"a"
.p2align 6
.amdhsa_kernel concat_heads__softmax_full_mha__mha_block__prompt_kernel
  .amdhsa_next_free_vgpr 256
  .amdhsa_next_free_sgpr 102
  .amdhsa_accum_offset 256
  .amdhsa_group_segment_fixed_size 0
  .amdhsa_kernarg_size 72
  .amdhsa_user_sgpr_count 2
  .amdhsa_user_sgpr_kernarg_segment_ptr 1
  .amdhsa_system_sgpr_workgroup_id_x 1
.end_amdhsa_kernel
```
